```python
import torch

def _softmax(x, axis=-1):
    return torch.softmax(x, dim=axis)
def _gelu(x):
    return torch.nn.functional.gelu(x, approximate="tanh")
def _silu(x):
    return torch.nn.functional.silu(x)
def _sigmoid(x):
    return torch.sigmoid(x)
def _layernorm(x, axis=-1, eps=1e-5):
    m = x.mean(dim=axis, keepdim=True)
    v = x.var(dim=axis, keepdim=True, unbiased=False)
    return (x - m) / torch.sqrt(v + eps)
def _scatter_add(tgt, idx, src, axis=0):
    return tgt.clone().index_add_(axis, idx, src)
def _segment_sum(src, seg, n):
    out = torch.zeros((n,) + src.shape[1:], dtype=src.dtype)
    return out.index_add_(0, seg, src)
def _pad(x, pw):
    flat = tuple(v for pair in reversed(pw) for v in pair)
    return torch.nn.functional.pad(x, flat)

kernel_name = 'standalone__gqa_block_cached__near_ridge'

def setup_inputs():

    _w = (lambda a: (lambda t: t.to(torch.bfloat16) if t.is_floating_point() else t)(torch.as_tensor(a)))
    B, Sq, D = 16, 80, 448
    Hq, Hkv, Sk, Dh = 16, 8, 512, 256
    assert Hq % Hkv == 0, (Hq, Hkv)
    return {
        "x": _w((lambda *s: torch.randn(*s, dtype=torch.bfloat16) * 0.8)(B, Sq, D)),
        "k_cache": _w((lambda *s: torch.randn(*s, dtype=torch.bfloat16) * 0.8)(B, Hkv, Sk, Dh)),
        "v_cache": _w((lambda *s: torch.randn(*s, dtype=torch.bfloat16) * 0.05)(B, Hkv, Sk, Dh)),
        "wq": _w((lambda *s: torch.randn(*s, dtype=torch.bfloat16) * 0.8)(D, Hq * Dh) * (D ** -0.5)),
        "wo": _w((lambda *s: torch.randn(*s, dtype=torch.bfloat16) * 0.05)(Hq * Dh, D) * ((Hq * Dh) ** -0.5)),
    }

def reference(x, k_cache, v_cache, wq, wo):
    B, Sq, D = x.shape
    Hq, Dh = 16, 256
    Hkv = k_cache.shape[1]
    rep = Hq // Hkv
    q = (lambda x, *d: x.permute(*d))((x @ wq).reshape(B, Sq, Hq, Dh), 0, 2, 1, 3)
    k = (lambda x, n, axis: torch.repeat_interleave(x, n, dim=axis))(k_cache, rep, axis=1)
    v = (lambda x, n, axis: torch.repeat_interleave(x, n, dim=axis))(v_cache, rep, axis=1)
    scores = torch.einsum("bhqd,bhkd->bhqk", q, k) * (Dh ** -0.5)
    p = _softmax(scores, axis=-1)
    o = torch.einsum("bhqk,bhkd->bhqd", p, v)
    return (lambda x, *d: x.permute(*d))(o, 0, 2, 1, 3).reshape(B, Sq, Hq * Dh) @ wo
```

```asm
; @launch kernel=attn_kernel grid=(256,1,1) block=(256,1,1) lds=163840
; @launch kernel=oproj_kernel grid=(1120,1,1) block=(64,1,1) lds=0
.amdgcn_target "amdgcn-amd-amdhsa--gfx950"
.text
.p2align 8
.globl attn_kernel
.type attn_kernel,@function
attn_kernel:
    s_cmp_ge_u32 s2, 256
    s_cbranch_scc1 L_attn_end
    s_load_dwordx16 s[4:19], s[0:1], 0
    s_getpc_b64 s[94:95]
    s_and_b32 s94, s94, 0xffffff00
    s_lshr_b32 s93, s2, 3
    s_mul_i32 s93, s93, 2048
    v_mul_u32_u24 v44, 8, v0
    v_add_u32 v44, s93, v44
    v_min_u32 v44, L_code_end-attn_kernel-16, v44
    global_load_dwordx2 v[48:49], v44, s[94:95]
    v_lshrrev_b32 v23, 6, v0
    v_and_b32 v1, 63, v0
    v_readfirstlane_b32 s40, v23
    s_bfe_u32 s43, s2, 65538
    s_lshl_b32 s43, s43, 3
    s_lshr_b32 s76, s2, 5
    s_add_u32 s43, s43, s76
    s_bfe_u32 s47, s2, 131075
    s_and_b32 s46, s2, 3
    s_lshl_b32 s44, s46, 2
    s_add_u32 s44, s44, s47
    s_lshr_b32 s41, s44, 1
    s_lshl_b32 s47, s47, 1
    s_add_u32 s47, s47, s76
    s_sub_u32 s53, s47, 7
    s_cmp_ge_u32 s47, 7
    s_cselect_b32 s92, s53, s47
    v_lshrrev_b32 v23, 3, v1
    v_and_b32 v25, 7, v1
    v_lshrrev_b32 v27, 1, v23
    v_xor_b32 v27, v27, v25
    v_lshlrev_b32 v27, 4, v27
    s_and_b32 s52, s40, 1
    v_mul_u32_u24 v36, 896, v23
    s_lshl_b32 s46, s52, 6
    v_xor_b32 v29, s46, v27
    v_add_u32 v36, v36, v29
    s_mul_i32 s46, s52, 7168
    v_add_u32 v36, s46, v36
    s_lshr_b32 s42, s40, 1
    s_mul_i32 s54, s42, 10240
    s_lshl_b32 s46, s52, 10
    s_add_u32 s54, s54, s46
    s_add_u32 s46, s42, s92
    s_add_u32 s47, s46, 0
    s_sub_u32 s53, s47, 7
    s_cmp_ge_u32 s47, 7
    s_cselect_b32 s52, s53, s47
    s_lshl_b32 s88, s52, 7
    s_add_u32 s47, s46, 2
    s_sub_u32 s53, s47, 7
    s_cmp_ge_u32 s47, 7
    s_cselect_b32 s52, s53, s47
    s_lshl_b32 s89, s52, 7
    s_add_u32 s47, s46, 4
    s_sub_u32 s53, s47, 7
    s_cmp_ge_u32 s47, 7
    s_cselect_b32 s52, s53, s47
    s_lshl_b32 s90, s52, 7
    s_add_u32 s47, s46, 6
    s_sub_u32 s53, s47, 7
    s_cmp_ge_u32 s47, 7
    s_cselect_b32 s52, s53, s47
    s_lshl_b32 s91, s52, 7
    s_cmp_eq_u32 s42, 1
    s_cselect_b32 s91, 1073741824, s91
    s_mul_i32 s48, s40, 18432
    s_add_u32 s48, s48, 81920
    s_mul_i32 s47, s43, 71680
    s_waitcnt lgkmcnt(0)
    s_add_u32 s20, s4, s47
    s_addc_u32 s21, s5, 0
    s_and_b32 s21, s21, 65535
    s_mov_b32 s22, 71680
    s_mov_b32 s23, 131072
    s_add_u32 m0, s54, 0
    s_add_u32 s47, s88, 0
    buffer_load_dwordx4 v36, s[20:23], s47 offen lds
    s_add_u32 m0, s54, 2048
    s_add_u32 s47, s88, 14336
    buffer_load_dwordx4 v36, s[20:23], s47 offen lds
    s_add_u32 m0, s54, 4096
    s_add_u32 s47, s88, 28672
    buffer_load_dwordx4 v36, s[20:23], s47 offen lds
    s_add_u32 m0, s54, 6144
    s_add_u32 s47, s88, 43008
    buffer_load_dwordx4 v36, s[20:23], s47 offen lds
    s_add_u32 m0, s54, 8192
    s_add_u32 s47, s88, 57344
    buffer_load_dwordx4 v36, s[20:23], s47 offen lds
    s_add_u32 s47, s92, 0
    s_sub_u32 s53, s47, 7
    s_cmp_ge_u32 s47, 7
    s_cselect_b32 s52, s53, s47
    s_lshl_b32 s80, s52, 19
    s_add_u32 s47, s92, 1
    s_sub_u32 s53, s47, 7
    s_cmp_ge_u32 s47, 7
    s_cselect_b32 s52, s53, s47
    s_lshl_b32 s81, s52, 19
    s_add_u32 s47, s92, 2
    s_sub_u32 s53, s47, 7
    s_cmp_ge_u32 s47, 7
    s_cselect_b32 s52, s53, s47
    s_lshl_b32 s82, s52, 19
    s_add_u32 s47, s92, 3
    s_sub_u32 s53, s47, 7
    s_cmp_ge_u32 s47, 7
    s_cselect_b32 s52, s53, s47
    s_lshl_b32 s83, s52, 19
    s_add_u32 s47, s92, 4
    s_sub_u32 s53, s47, 7
    s_cmp_ge_u32 s47, 7
    s_cselect_b32 s52, s53, s47
    s_lshl_b32 s84, s52, 19
    s_add_u32 s47, s92, 5
    s_sub_u32 s53, s47, 7
    s_cmp_ge_u32 s47, 7
    s_cselect_b32 s52, s53, s47
    s_lshl_b32 s85, s52, 19
    s_add_u32 s47, s92, 6
    s_sub_u32 s53, s47, 7
    s_cmp_ge_u32 s47, 7
    s_cselect_b32 s52, s53, s47
    s_lshl_b32 s86, s52, 19
    s_lshl_b32 s47, s44, 9
    s_lshl_b32 s52, s40, 7
    s_add_u32 s47, s47, s52
    s_sub_u32 s53, 3670016, s47
    s_add_u32 s24, s10, s47
    s_addc_u32 s25, s11, 0
    s_and_b32 s25, s25, 65535
    s_mov_b32 s26, s53
    s_mov_b32 s27, 131072
    v_lshl_add_u32 v4, v23, 9, v27
    v_xor_b32 v5, 64, v4
    v_add_u32 v5, 3072, v5
    v_and_b32 v27, 6, v23
    v_xor_b32 v27, v27, v25
    v_lshlrev_b32 v27, 4, v27
    v_lshl_add_u32 v8, v23, 9, v27
    v_add_u32 v9, 3072, v8
    v_and_b32 v29, 3, v23
    v_lshrrev_b32 v31, 2, v23
    v_lshl_add_u32 v29, v31, 3, v29
    v_lshl_add_u32 v6, v29, 13, v27
    v_add_u32 v7, 130048, v6
    s_add_u32 m0, s48, 0
    s_add_u32 s47, s80, 0
    buffer_load_dwordx4 v6, s[24:27], s47 offen lds
    buffer_load_dwordx4 v7, s[24:27], s47 offen offset:1024 lds
    s_add_u32 m0, s48, 2048
    s_add_u32 s47, s80, 32768
    buffer_load_dwordx4 v6, s[24:27], s47 offen lds
    buffer_load_dwordx4 v7, s[24:27], s47 offen offset:1024 lds
    s_add_u32 m0, s48, 4096
    s_add_u32 s47, s80, 262144
    buffer_load_dwordx4 v6, s[24:27], s47 offen lds
    buffer_load_dwordx4 v7, s[24:27], s47 offen offset:1024 lds
    s_add_u32 m0, s48, 6144
    s_add_u32 s47, s80, 294912
    buffer_load_dwordx4 v6, s[24:27], s47 offen lds
    buffer_load_dwordx4 v7, s[24:27], s47 offen offset:1024 lds
    s_lshl_b32 s46, s43, 3
    s_add_u32 s46, s46, s41
    s_lshl_b32 s55, s46, 18
    s_lshl_b32 s47, s40, 16
    s_add_u32 s47, s47, s55
    s_add_u32 s28, s6, s47
    s_addc_u32 s29, s7, 0
    s_and_b32 s29, s29, 65535
    s_mov_b32 s30, 65536
    s_mov_b32 s31, 131072
    s_lshl_b32 s52, s40, 7
    s_add_u32 s46, s55, s52
    s_sub_u32 s53, 262144, s52
    s_add_u32 s32, s8, s46
    s_addc_u32 s33, s9, 0
    s_and_b32 s33, s33, 65535
    s_mov_b32 s34, s53
    s_mov_b32 s35, 131072
    v_and_b32 v2, 15, v1
    v_lshrrev_b32 v3, 4, v1
    v_lshrrev_b32 v23, 2, v2
    v_lshl_add_u32 v23, v3, 2, v23
    v_and_b32 v25, 3, v2
    v_lshlrev_b32 v25, 3, v25
    v_lshl_add_u32 v25, v23, 7, v25
    v_add_u32 v25, s48, v25
    v_bfe_u32 v27, v23, 1, 2
    v_xor_b32 v29, 0, v27
    v_lshl_add_u32 v10, v29, 5, v25
    v_xor_b32 v29, 1, v27
    v_lshl_add_u32 v11, v29, 5, v25
    v_xor_b32 v29, 2, v27
    v_lshl_add_u32 v12, v29, 5, v25
    v_xor_b32 v29, 3, v27
    v_lshl_add_u32 v13, v29, 5, v25
    v_lshrrev_b32 v23, 1, v2
    v_xor_b32 v23, v23, v3
    v_lshlrev_b32 v23, 4, v23
    v_lshl_add_u32 v32, v2, 7, v23
    v_xor_b32 v33, 64, v32
    v_add_u32 v34, 40960, v32
    v_add_u32 v35, 40960, v33
    v_add_u32 v14, s48, v32
    v_add_u32 v15, s48, v33
    v_lshlrev_b32 v16, 4, v1
    v_add_u32 v17, 40960, v16
    v_lshlrev_b32 v18, 4, v2
    v_lshrrev_b32 v23, 1, v3
    v_lshl_add_u32 v18, v23, 8, v18
    v_and_b32 v23, 1, v3
    v_lshl_add_u32 v18, v23, 3, v18
    s_mul_i32 s47, s40, 10240
    v_add_u32 v18, s47, v18
    v_lshlrev_b32 v20, 4, v2
    v_add_u32 v20, 155648, v20
    s_lshl_b32 s47, s40, 2
    v_add_u32 v19, s47, v20
    s_mul_i32 s47, s40, 10240
    v_add_u32 v21, s47, v16
    s_mov_b32 s50, 1035512379
    s_mov_b32 s51, 1035512379
    s_mul_i32 s46, s43, 7
    s_lshl_b32 s47, s40, 1
    s_add_u32 s46, s46, s47
    s_mul_i32 s46, s46, 163840
    s_lshl_b32 s47, s44, 10
    s_add_u32 s46, s46, s47
    s_add_u32 s36, s18, s46
    s_addc_u32 s37, s19, 0
    s_and_b32 s37, s37, 65535
    s_mov_b32 s38, 327680
    s_mov_b32 s39, 131072
    s_mul_i32 s46, s44, 229376
    s_lshl_b32 s47, s40, 8
    s_add_u32 s46, s46, s47
    s_sub_u32 s53, 3670016, s46
    s_add_u32 s56, s12, s46
    s_addc_u32 s57, s13, 0
    s_and_b32 s57, s57, 65535
    s_mov_b32 s58, s53
    s_mov_b32 s59, 131072
    s_add_u32 s46, s46, 128
    s_sub_u32 s53, 3670016, s46
    s_cmp_eq_u32 s40, 3
    s_cselect_b32 s53, 0, s53
    s_cselect_b32 s46, 0, s46
    s_add_u32 s64, s12, s46
    s_addc_u32 s65, s13, 0
    s_and_b32 s65, s65, 65535
    s_mov_b32 s66, s53
    s_mov_b32 s67, 131072
    s_add_u32 s47, s76, 0
    s_and_b32 s47, s47, 7
    s_mul_i32 s68, s47, 28672
    s_add_u32 s47, s76, 1
    s_and_b32 s47, s47, 7
    s_mul_i32 s69, s47, 28672
    s_add_u32 s47, s76, 2
    s_and_b32 s47, s47, 7
    s_mul_i32 s70, s47, 28672
    s_add_u32 s47, s76, 3
    s_and_b32 s47, s47, 7
    s_mul_i32 s71, s47, 28672
    s_add_u32 s47, s76, 4
    s_and_b32 s47, s47, 7
    s_mul_i32 s72, s47, 28672
    s_add_u32 s47, s76, 5
    s_and_b32 s47, s47, 7
    s_mul_i32 s73, s47, 28672
    s_add_u32 s47, s76, 6
    s_and_b32 s47, s47, 7
    s_mul_i32 s74, s47, 28672
    s_add_u32 s47, s76, 7
    s_and_b32 s47, s47, 7
    s_mul_i32 s75, s47, 28672
    s_waitcnt vmcnt(8)
    s_add_u32 m0, s54, 20480
    s_add_u32 s47, s89, 0
    buffer_load_dwordx4 v36, s[20:23], s47 offen lds
    s_add_u32 m0, s54, 22528
    s_add_u32 s47, s89, 14336
    buffer_load_dwordx4 v36, s[20:23], s47 offen lds
    s_add_u32 m0, s54, 24576
    s_add_u32 s47, s89, 28672
    buffer_load_dwordx4 v36, s[20:23], s47 offen lds
    s_add_u32 m0, s54, 26624
    s_add_u32 s47, s89, 43008
    buffer_load_dwordx4 v36, s[20:23], s47 offen lds
    s_add_u32 m0, s54, 28672
    s_add_u32 s47, s89, 57344
    buffer_load_dwordx4 v36, s[20:23], s47 offen lds
    s_barrier
    ds_read_b128 a[96:99], v32
    ds_read_b128 a[100:103], v32 offset:2048
    ds_read_b128 a[104:107], v32 offset:4096
    ds_read_b128 a[108:111], v32 offset:6144
    ds_read_b128 a[112:115], v32 offset:8192
    s_waitcnt vmcnt(11)
    ds_read_b64_tr_b16 v[128:129], v10
    ds_read_b64_tr_b16 v[132:133], v11
    ds_read_b64_tr_b16 v[136:137], v12
    ds_read_b64_tr_b16 v[140:141], v13
    s_waitcnt vmcnt(9)
    ds_read_b64_tr_b16 v[130:131], v10 offset:2048
    ds_read_b64_tr_b16 v[134:135], v11 offset:2048
    ds_read_b64_tr_b16 v[138:139], v12 offset:2048
    ds_read_b64_tr_b16 v[142:143], v13 offset:2048
    s_add_u32 m0, s48, 8192
    s_add_u32 s47, s81, 0
    buffer_load_dwordx4 v6, s[24:27], s47 offen lds
    buffer_load_dwordx4 v7, s[24:27], s47 offen offset:1024 lds
    s_waitcnt lgkmcnt(0)
    v_mfma_f32_16x16x32_bf16 v[44:47], v[128:131], a[96:99], 0
    v_mfma_f32_16x16x32_bf16 v[64:67], v[132:135], a[96:99], 0
    ds_read_b128 a[132:135], v33
    v_mfma_f32_16x16x32_bf16 v[84:87], v[136:139], a[96:99], 0
    ds_read_b128 a[136:139], v33 offset:2048
    v_mfma_f32_16x16x32_bf16 v[104:107], v[140:143], a[96:99], 0
    ds_read_b128 a[140:143], v33 offset:4096
    v_mfma_f32_16x16x32_bf16 v[48:51], v[128:131], a[100:103], 0
    v_mfma_f32_16x16x32_bf16 v[68:71], v[132:135], a[100:103], 0
    ds_read_b128 a[144:147], v33 offset:6144
    v_mfma_f32_16x16x32_bf16 v[88:91], v[136:139], a[100:103], 0
    ds_read_b128 a[148:151], v33 offset:8192
    v_mfma_f32_16x16x32_bf16 v[108:111], v[140:143], a[100:103], 0
    v_mfma_f32_16x16x32_bf16 v[52:55], v[128:131], a[104:107], 0
    v_mfma_f32_16x16x32_bf16 v[72:75], v[132:135], a[104:107], 0
    v_mfma_f32_16x16x32_bf16 v[92:95], v[136:139], a[104:107], 0
    v_mfma_f32_16x16x32_bf16 v[112:115], v[140:143], a[104:107], 0
    v_mfma_f32_16x16x32_bf16 v[56:59], v[128:131], a[108:111], 0
    v_mfma_f32_16x16x32_bf16 v[76:79], v[132:135], a[108:111], 0
    v_mfma_f32_16x16x32_bf16 v[96:99], v[136:139], a[108:111], 0
    v_mfma_f32_16x16x32_bf16 v[116:119], v[140:143], a[108:111], 0
    s_waitcnt vmcnt(9)
    ds_read_b64_tr_b16 v[144:145], v10 offset:4096
    ds_read_b64_tr_b16 v[148:149], v11 offset:4096
    ds_read_b64_tr_b16 v[152:153], v12 offset:4096
    ds_read_b64_tr_b16 v[156:157], v13 offset:4096
    s_add_u32 m0, s48, 10240
    s_add_u32 s47, s81, 32768
    buffer_load_dwordx4 v6, s[24:27], s47 offen lds
    buffer_load_dwordx4 v7, s[24:27], s47 offen offset:1024 lds
    s_waitcnt vmcnt(9)
    ds_read_b64_tr_b16 v[146:147], v10 offset:6144
    ds_read_b64_tr_b16 v[150:151], v11 offset:6144
    ds_read_b64_tr_b16 v[154:155], v12 offset:6144
    ds_read_b64_tr_b16 v[158:159], v13 offset:6144
    s_add_u32 m0, s48, 12288
    s_add_u32 s47, s81, 262144
    buffer_load_dwordx4 v6, s[24:27], s47 offen lds
    buffer_load_dwordx4 v7, s[24:27], s47 offen offset:1024 lds
    v_mfma_f32_16x16x32_bf16 v[60:63], v[128:131], a[112:115], 0
    v_mfma_f32_16x16x32_bf16 v[80:83], v[132:135], a[112:115], 0
    v_mfma_f32_16x16x32_bf16 v[100:103], v[136:139], a[112:115], 0
    v_mfma_f32_16x16x32_bf16 v[120:123], v[140:143], a[112:115], 0
    s_waitcnt lgkmcnt(0)
    v_mfma_f32_16x16x32_bf16 v[44:47], v[144:147], a[132:135], v[44:47]
    v_mfma_f32_16x16x32_bf16 v[64:67], v[148:151], a[132:135], v[64:67]
    ds_read_b128 a[96:99], v32 offset:10240
    v_mfma_f32_16x16x32_bf16 v[84:87], v[152:155], a[132:135], v[84:87]
    ds_read_b128 a[100:103], v32 offset:12288
    v_mfma_f32_16x16x32_bf16 v[104:107], v[156:159], a[132:135], v[104:107]
    ds_read_b128 a[104:107], v32 offset:14336
    v_mfma_f32_16x16x32_bf16 v[48:51], v[144:147], a[136:139], v[48:51]
    v_mfma_f32_16x16x32_bf16 v[68:71], v[148:151], a[136:139], v[68:71]
    ds_read_b128 a[108:111], v32 offset:16384
    v_mfma_f32_16x16x32_bf16 v[88:91], v[152:155], a[136:139], v[88:91]
    ds_read_b128 a[112:115], v32 offset:18432
    v_mfma_f32_16x16x32_bf16 v[108:111], v[156:159], a[136:139], v[108:111]
    v_mfma_f32_16x16x32_bf16 v[52:55], v[144:147], a[140:143], v[52:55]
    v_mfma_f32_16x16x32_bf16 v[72:75], v[148:151], a[140:143], v[72:75]
    v_mfma_f32_16x16x32_bf16 v[92:95], v[152:155], a[140:143], v[92:95]
    v_mfma_f32_16x16x32_bf16 v[112:115], v[156:159], a[140:143], v[112:115]
    v_mfma_f32_16x16x32_bf16 v[56:59], v[144:147], a[144:147], v[56:59]
    s_add_u32 m0, s48, 14336
    s_add_u32 s47, s81, 294912
    buffer_load_dwordx4 v6, s[24:27], s47 offen lds
    buffer_load_dwordx4 v7, s[24:27], s47 offen offset:1024 lds
    v_mfma_f32_16x16x32_bf16 v[76:79], v[148:151], a[144:147], v[76:79]
    s_add_u32 m0, s48, 16384
    s_add_u32 s47, s82, 0
    buffer_load_dwordx4 v6, s[24:27], s47 offen lds
    buffer_load_dwordx4 v7, s[24:27], s47 offen offset:1024 lds
    v_mfma_f32_16x16x32_bf16 v[96:99], v[152:155], a[144:147], v[96:99]
    s_waitcnt vmcnt(10)
    v_mfma_f32_16x16x32_bf16 v[116:119], v[156:159], a[144:147], v[116:119]
    s_waitcnt vmcnt(8)
    ds_read_b64_tr_b16 v[160:161], v10 offset:8192
    ds_read_b64_tr_b16 v[164:165], v11 offset:8192
    ds_read_b64_tr_b16 v[168:169], v12 offset:8192
    ds_read_b64_tr_b16 v[172:173], v13 offset:8192
    s_add_u32 m0, s48, 0
    s_add_u32 s47, s82, 32768
    buffer_load_dwordx4 v6, s[24:27], s47 offen lds
    buffer_load_dwordx4 v7, s[24:27], s47 offen offset:1024 lds
    s_waitcnt vmcnt(8)
    ds_read_b64_tr_b16 v[162:163], v10 offset:10240
    ds_read_b64_tr_b16 v[166:167], v11 offset:10240
    ds_read_b64_tr_b16 v[170:171], v12 offset:10240
    ds_read_b64_tr_b16 v[174:175], v13 offset:10240
    s_add_u32 m0, s48, 2048
    s_add_u32 s47, s82, 262144
    buffer_load_dwordx4 v6, s[24:27], s47 offen lds
    buffer_load_dwordx4 v7, s[24:27], s47 offen offset:1024 lds
    v_mfma_f32_16x16x32_bf16 v[60:63], v[144:147], a[148:151], v[60:63]
    v_mfma_f32_16x16x32_bf16 v[80:83], v[148:151], a[148:151], v[80:83]
    v_mfma_f32_16x16x32_bf16 v[100:103], v[152:155], a[148:151], v[100:103]
    v_mfma_f32_16x16x32_bf16 v[120:123], v[156:159], a[148:151], v[120:123]
    s_waitcnt lgkmcnt(0)
    v_mfma_f32_16x16x32_bf16 v[44:47], v[160:163], a[96:99], v[44:47]
    v_mfma_f32_16x16x32_bf16 v[64:67], v[164:167], a[96:99], v[64:67]
    ds_read_b128 a[132:135], v33 offset:10240
    s_add_u32 m0, s48, 4096
    s_add_u32 s47, s82, 294912
    buffer_load_dwordx4 v6, s[24:27], s47 offen lds
    buffer_load_dwordx4 v7, s[24:27], s47 offen offset:1024 lds
    v_mfma_f32_16x16x32_bf16 v[84:87], v[168:171], a[96:99], v[84:87]
    ds_read_b128 a[136:139], v33 offset:12288
    s_waitcnt vmcnt(10)
    v_mfma_f32_16x16x32_bf16 v[104:107], v[172:175], a[96:99], v[104:107]
    ds_read_b128 a[140:143], v33 offset:14336
    ds_read_b64_tr_b16 v[176:177], v10 offset:12288
    v_mfma_f32_16x16x32_bf16 v[48:51], v[160:163], a[100:103], v[48:51]
    ds_read_b64_tr_b16 v[180:181], v11 offset:12288
    ds_read_b64_tr_b16 v[184:185], v12 offset:12288
    v_mfma_f32_16x16x32_bf16 v[68:71], v[164:167], a[100:103], v[68:71]
    ds_read_b128 a[144:147], v33 offset:16384
    ds_read_b64_tr_b16 v[188:189], v13 offset:12288
    v_mfma_f32_16x16x32_bf16 v[88:91], v[168:171], a[100:103], v[88:91]
    ds_read_b128 a[148:151], v33 offset:18432
    v_mfma_f32_16x16x32_bf16 v[108:111], v[172:175], a[100:103], v[108:111]
    v_mfma_f32_16x16x32_bf16 v[52:55], v[160:163], a[104:107], v[52:55]
    v_mfma_f32_16x16x32_bf16 v[72:75], v[164:167], a[104:107], v[72:75]
    v_mfma_f32_16x16x32_bf16 v[92:95], v[168:171], a[104:107], v[92:95]
    v_mfma_f32_16x16x32_bf16 v[112:115], v[172:175], a[104:107], v[112:115]
    v_mfma_f32_16x16x32_bf16 v[56:59], v[160:163], a[108:111], v[56:59]
    v_mfma_f32_16x16x32_bf16 v[76:79], v[164:167], a[108:111], v[76:79]
    v_mfma_f32_16x16x32_bf16 v[96:99], v[168:171], a[108:111], v[96:99]
    v_mfma_f32_16x16x32_bf16 v[116:119], v[172:175], a[108:111], v[116:119]
    s_waitcnt vmcnt(8)
    ds_read_b64_tr_b16 v[178:179], v10 offset:14336
    ds_read_b64_tr_b16 v[182:183], v11 offset:14336
    ds_read_b64_tr_b16 v[186:187], v12 offset:14336
    ds_read_b64_tr_b16 v[190:191], v13 offset:14336
    s_add_u32 m0, s54, 40960
    s_add_u32 s47, s90, 0
    buffer_load_dwordx4 v36, s[20:23], s47 offen lds
    s_add_u32 m0, s54, 43008
    s_add_u32 s47, s90, 14336
    buffer_load_dwordx4 v36, s[20:23], s47 offen lds
    s_add_u32 m0, s54, 45056
    s_add_u32 s47, s90, 28672
    buffer_load_dwordx4 v36, s[20:23], s47 offen lds
    s_add_u32 m0, s54, 47104
    s_add_u32 s47, s90, 43008
    buffer_load_dwordx4 v36, s[20:23], s47 offen lds
    s_add_u32 m0, s54, 49152
    s_add_u32 s47, s90, 57344
    buffer_load_dwordx4 v36, s[20:23], s47 offen lds
    v_mfma_f32_16x16x32_bf16 v[60:63], v[160:163], a[112:115], v[60:63]
    v_mfma_f32_16x16x32_bf16 v[80:83], v[164:167], a[112:115], v[80:83]
    v_mfma_f32_16x16x32_bf16 v[100:103], v[168:171], a[112:115], v[100:103]
    s_waitcnt vmcnt(11)
    ds_read_b64_tr_b16 v[192:193], v10 offset:16384
    v_mfma_f32_16x16x32_bf16 v[120:123], v[172:175], a[112:115], v[120:123]
    ds_read_b64_tr_b16 v[196:197], v11 offset:16384
    ds_read_b64_tr_b16 v[200:201], v12 offset:16384
    s_waitcnt lgkmcnt(3)
    v_mfma_f32_16x16x32_bf16 v[44:47], v[176:179], a[132:135], v[44:47]
    ds_read_b64_tr_b16 v[204:205], v13 offset:16384
    v_mfma_f32_16x16x32_bf16 v[64:67], v[180:183], a[132:135], v[64:67]
    s_barrier
    v_mfma_f32_16x16x32_bf16 v[84:87], v[184:187], a[132:135], v[84:87]
    ds_read_b128 a[96:99], v32 offset:20480
    v_mfma_f32_16x16x32_bf16 v[104:107], v[188:191], a[132:135], v[104:107]
    ds_read_b128 a[100:103], v32 offset:22528
    v_mfma_f32_16x16x32_bf16 v[48:51], v[176:179], a[136:139], v[48:51]
    ds_read_b128 a[104:107], v32 offset:24576
    v_mfma_f32_16x16x32_bf16 v[68:71], v[180:183], a[136:139], v[68:71]
    s_add_u32 m0, s48, 6144
    s_add_u32 s47, s83, 0
    buffer_load_dwordx4 v6, s[24:27], s47 offen lds
    buffer_load_dwordx4 v7, s[24:27], s47 offen offset:1024 lds
    v_mfma_f32_16x16x32_bf16 v[88:91], v[184:187], a[136:139], v[88:91]
    ds_read_b128 a[108:111], v32 offset:26624
    s_waitcnt vmcnt(11)
    v_mfma_f32_16x16x32_bf16 v[108:111], v[188:191], a[136:139], v[108:111]
    ds_read_b128 a[112:115], v32 offset:28672
    ds_read_b64_tr_b16 v[194:195], v10
    v_mfma_f32_16x16x32_bf16 v[52:55], v[176:179], a[140:143], v[52:55]
    ds_read_b64_tr_b16 v[198:199], v11
    ds_read_b64_tr_b16 v[202:203], v12
    v_mfma_f32_16x16x32_bf16 v[72:75], v[180:183], a[140:143], v[72:75]
    ds_read_b64_tr_b16 v[206:207], v13
    v_mfma_f32_16x16x32_bf16 v[92:95], v[184:187], a[140:143], v[92:95]
    v_mfma_f32_16x16x32_bf16 v[112:115], v[188:191], a[140:143], v[112:115]
    v_mfma_f32_16x16x32_bf16 v[56:59], v[176:179], a[144:147], v[56:59]
    s_add_u32 m0, s48, 8192
    s_add_u32 s47, s83, 32768
    buffer_load_dwordx4 v6, s[24:27], s47 offen lds
    buffer_load_dwordx4 v7, s[24:27], s47 offen offset:1024 lds
    v_mfma_f32_16x16x32_bf16 v[76:79], v[180:183], a[144:147], v[76:79]
    s_waitcnt vmcnt(11)
    ds_read_b64_tr_b16 v[208:209], v10 offset:2048
    v_mfma_f32_16x16x32_bf16 v[96:99], v[184:187], a[144:147], v[96:99]
    ds_read_b64_tr_b16 v[212:213], v11 offset:2048
    ds_read_b64_tr_b16 v[216:217], v12 offset:2048
    v_mfma_f32_16x16x32_bf16 v[116:119], v[188:191], a[144:147], v[116:119]
    ds_read_b64_tr_b16 v[220:221], v13 offset:2048
    v_mfma_f32_16x16x32_bf16 v[60:63], v[176:179], a[148:151], v[60:63]
    v_mfma_f32_16x16x32_bf16 v[80:83], v[180:183], a[148:151], v[80:83]
    v_mfma_f32_16x16x32_bf16 v[100:103], v[184:187], a[148:151], v[100:103]
    s_add_u32 m0, s48, 10240
    s_add_u32 s47, s83, 262144
    buffer_load_dwordx4 v6, s[24:27], s47 offen lds
    buffer_load_dwordx4 v7, s[24:27], s47 offen offset:1024 lds
    v_mfma_f32_16x16x32_bf16 v[120:123], v[188:191], a[148:151], v[120:123]
    s_waitcnt vmcnt(11)
    ds_read_b64_tr_b16 v[210:211], v10 offset:4096
    s_waitcnt lgkmcnt(5)
    v_mfma_f32_16x16x32_bf16 v[44:47], v[192:195], a[96:99], v[44:47]
    ds_read_b64_tr_b16 v[214:215], v11 offset:4096
    ds_read_b64_tr_b16 v[218:219], v12 offset:4096
    v_mfma_f32_16x16x32_bf16 v[64:67], v[196:199], a[96:99], v[64:67]
    ds_read_b128 a[132:135], v33 offset:20480
    ds_read_b64_tr_b16 v[222:223], v13 offset:4096
    v_mfma_f32_16x16x32_bf16 v[84:87], v[200:203], a[96:99], v[84:87]
    ds_read_b128 a[136:139], v33 offset:22528
    v_mfma_f32_16x16x32_bf16 v[104:107], v[204:207], a[96:99], v[104:107]
    ds_read_b128 a[140:143], v33 offset:24576
    v_mfma_f32_16x16x32_bf16 v[48:51], v[192:195], a[100:103], v[48:51]
    v_mfma_f32_16x16x32_bf16 v[68:71], v[196:199], a[100:103], v[68:71]
    ds_read_b128 a[144:147], v33 offset:26624
    v_mfma_f32_16x16x32_bf16 v[88:91], v[200:203], a[100:103], v[88:91]
    ds_read_b128 a[148:151], v33 offset:28672
    v_mfma_f32_16x16x32_bf16 v[108:111], v[204:207], a[100:103], v[108:111]
    v_mfma_f32_16x16x32_bf16 v[52:55], v[192:195], a[104:107], v[52:55]
    v_mfma_f32_16x16x32_bf16 v[72:75], v[196:199], a[104:107], v[72:75]
    v_mfma_f32_16x16x32_bf16 v[92:95], v[200:203], a[104:107], v[92:95]
    v_mfma_f32_16x16x32_bf16 v[112:115], v[204:207], a[104:107], v[112:115]
    v_mfma_f32_16x16x32_bf16 v[56:59], v[192:195], a[108:111], v[56:59]
    v_mfma_f32_16x16x32_bf16 v[76:79], v[196:199], a[108:111], v[76:79]
    v_mfma_f32_16x16x32_bf16 v[96:99], v[200:203], a[108:111], v[96:99]
    v_mfma_f32_16x16x32_bf16 v[116:119], v[204:207], a[108:111], v[116:119]
    s_add_u32 m0, s48, 12288
    s_add_u32 s47, s83, 294912
    buffer_load_dwordx4 v6, s[24:27], s47 offen lds
    buffer_load_dwordx4 v7, s[24:27], s47 offen offset:1024 lds
    v_mfma_f32_16x16x32_bf16 v[60:63], v[192:195], a[112:115], v[60:63]
    s_add_u32 m0, s48, 14336
    s_add_u32 s47, s84, 0
    buffer_load_dwordx4 v6, s[24:27], s47 offen lds
    buffer_load_dwordx4 v7, s[24:27], s47 offen offset:1024 lds
    v_mfma_f32_16x16x32_bf16 v[80:83], v[196:199], a[112:115], v[80:83]
    s_waitcnt vmcnt(10)
    v_mfma_f32_16x16x32_bf16 v[100:103], v[200:203], a[112:115], v[100:103]
    v_mfma_f32_16x16x32_bf16 v[120:123], v[204:207], a[112:115], v[120:123]
    s_waitcnt lgkmcnt(4)
    s_waitcnt lgkmcnt(0)
    v_mfma_f32_16x16x32_bf16 v[44:47], v[208:211], a[132:135], v[44:47]
    v_mfma_f32_16x16x32_bf16 v[64:67], v[212:215], a[132:135], v[64:67]
    ds_read_b128 a[96:99], v32 offset:30720
    s_add_u32 m0, s48, 16384
    s_add_u32 s47, s84, 32768
    buffer_load_dwordx4 v6, s[24:27], s47 offen lds
    buffer_load_dwordx4 v7, s[24:27], s47 offen offset:1024 lds
    v_mfma_f32_16x16x32_bf16 v[84:87], v[216:219], a[132:135], v[84:87]
    ds_read_b128 a[100:103], v32 offset:32768
    s_waitcnt vmcnt(10)
    v_mfma_f32_16x16x32_bf16 v[104:107], v[220:223], a[132:135], v[104:107]
    ds_read_b128 a[104:107], v32 offset:34816
    ds_read_b64_tr_b16 v[224:225], v10 offset:6144
    v_mfma_f32_16x16x32_bf16 v[48:51], v[208:211], a[136:139], v[48:51]
    ds_read_b64_tr_b16 v[228:229], v11 offset:6144
    ds_read_b64_tr_b16 v[232:233], v12 offset:6144
    v_mfma_f32_16x16x32_bf16 v[68:71], v[212:215], a[136:139], v[68:71]
    ds_read_b128 a[108:111], v32 offset:36864
    ds_read_b64_tr_b16 v[236:237], v13 offset:6144
    v_mfma_f32_16x16x32_bf16 v[88:91], v[216:219], a[136:139], v[88:91]
    ds_read_b128 a[112:115], v32 offset:38912
    v_mfma_f32_16x16x32_bf16 v[108:111], v[220:223], a[136:139], v[108:111]
    s_add_u32 m0, s48, 0
    s_add_u32 s47, s84, 262144
    buffer_load_dwordx4 v6, s[24:27], s47 offen lds
    buffer_load_dwordx4 v7, s[24:27], s47 offen offset:1024 lds
    v_mfma_f32_16x16x32_bf16 v[52:55], v[208:211], a[140:143], v[52:55]
    s_waitcnt vmcnt(10)
    ds_read_b64_tr_b16 v[226:227], v10 offset:8192
    v_mfma_f32_16x16x32_bf16 v[72:75], v[212:215], a[140:143], v[72:75]
    ds_read_b64_tr_b16 v[230:231], v11 offset:8192
    ds_read_b64_tr_b16 v[234:235], v12 offset:8192
    v_mfma_f32_16x16x32_bf16 v[92:95], v[216:219], a[140:143], v[92:95]
    ds_read_b64_tr_b16 v[238:239], v13 offset:8192
    v_mfma_f32_16x16x32_bf16 v[112:115], v[220:223], a[140:143], v[112:115]
    v_mfma_f32_16x16x32_bf16 v[56:59], v[208:211], a[144:147], v[56:59]
    v_mfma_f32_16x16x32_bf16 v[76:79], v[212:215], a[144:147], v[76:79]
    s_add_u32 m0, s48, 2048
    s_add_u32 s47, s84, 294912
    buffer_load_dwordx4 v6, s[24:27], s47 offen lds
    buffer_load_dwordx4 v7, s[24:27], s47 offen offset:1024 lds
    v_mfma_f32_16x16x32_bf16 v[96:99], v[216:219], a[144:147], v[96:99]
    s_waitcnt vmcnt(10)
    ds_read_b64_tr_b16 v[240:241], v10 offset:10240
    v_mfma_f32_16x16x32_bf16 v[116:119], v[220:223], a[144:147], v[116:119]
    ds_read_b64_tr_b16 v[244:245], v11 offset:10240
    ds_read_b64_tr_b16 v[248:249], v12 offset:10240
    v_mfma_f32_16x16x32_bf16 v[60:63], v[208:211], a[148:151], v[60:63]
    ds_read_b64_tr_b16 v[252:253], v13 offset:10240
    v_mfma_f32_16x16x32_bf16 v[80:83], v[212:215], a[148:151], v[80:83]
    v_mfma_f32_16x16x32_bf16 v[100:103], v[216:219], a[148:151], v[100:103]
    v_mfma_f32_16x16x32_bf16 v[120:123], v[220:223], a[148:151], v[120:123]
    s_waitcnt lgkmcnt(4)
    v_mfma_f32_16x16x32_bf16 v[44:47], v[224:227], a[96:99], v[44:47]
    v_mfma_f32_16x16x32_bf16 v[64:67], v[228:231], a[96:99], v[64:67]
    ds_read_b128 a[132:135], v33 offset:30720
    v_mfma_f32_16x16x32_bf16 v[84:87], v[232:235], a[96:99], v[84:87]
    ds_read_b128 a[136:139], v33 offset:32768
    v_mfma_f32_16x16x32_bf16 v[104:107], v[236:239], a[96:99], v[104:107]
    ds_read_b128 a[140:143], v33 offset:34816
    v_mfma_f32_16x16x32_bf16 v[48:51], v[224:227], a[100:103], v[48:51]
    v_mfma_f32_16x16x32_bf16 v[68:71], v[228:231], a[100:103], v[68:71]
    ds_read_b128 a[144:147], v33 offset:36864
    v_mfma_f32_16x16x32_bf16 v[88:91], v[232:235], a[100:103], v[88:91]
    ds_read_b128 a[148:151], v33 offset:38912
    v_mfma_f32_16x16x32_bf16 v[108:111], v[236:239], a[100:103], v[108:111]
    v_mfma_f32_16x16x32_bf16 v[52:55], v[224:227], a[104:107], v[52:55]
    s_add_u32 m0, s54, 61440
    s_add_u32 s47, s91, 0
    buffer_load_dwordx4 v36, s[20:23], s47 offen lds
    s_add_u32 m0, s54, 63488
    s_add_u32 s47, s91, 14336
    buffer_load_dwordx4 v36, s[20:23], s47 offen lds
    s_add_u32 m0, s54, 65536
    s_add_u32 s47, s91, 28672
    buffer_load_dwordx4 v36, s[20:23], s47 offen lds
    s_add_u32 m0, s54, 67584
    s_add_u32 s47, s91, 43008
    buffer_load_dwordx4 v36, s[20:23], s47 offen lds
    s_add_u32 m0, s54, 69632
    s_add_u32 s47, s91, 57344
    buffer_load_dwordx4 v36, s[20:23], s47 offen lds
    v_mfma_f32_16x16x32_bf16 v[72:75], v[228:231], a[104:107], v[72:75]
    s_waitcnt vmcnt(13)
    ds_read_b64_tr_b16 v[242:243], v10 offset:12288
    v_mfma_f32_16x16x32_bf16 v[92:95], v[232:235], a[104:107], v[92:95]
    ds_read_b64_tr_b16 v[246:247], v11 offset:12288
    ds_read_b64_tr_b16 v[250:251], v12 offset:12288
    v_mfma_f32_16x16x32_bf16 v[112:115], v[236:239], a[104:107], v[112:115]
    ds_read_b64_tr_b16 v[254:255], v13 offset:12288
    v_mfma_f32_16x16x32_bf16 v[56:59], v[224:227], a[108:111], v[56:59]
    s_waitcnt vmcnt(11)
    ds_read_b64_tr_b16 v[128:129], v10 offset:14336
    v_mfma_f32_16x16x32_bf16 v[76:79], v[228:231], a[108:111], v[76:79]
    ds_read_b64_tr_b16 v[132:133], v11 offset:14336
    ds_read_b64_tr_b16 v[136:137], v12 offset:14336
    v_mfma_f32_16x16x32_bf16 v[96:99], v[232:235], a[108:111], v[96:99]
    ds_read_b64_tr_b16 v[140:141], v13 offset:14336
    v_mfma_f32_16x16x32_bf16 v[116:119], v[236:239], a[108:111], v[116:119]
    v_mfma_f32_16x16x32_bf16 v[60:63], v[224:227], a[112:115], v[60:63]
    v_mfma_f32_16x16x32_bf16 v[80:83], v[228:231], a[112:115], v[80:83]
    v_mfma_f32_16x16x32_bf16 v[100:103], v[232:235], a[112:115], v[100:103]
    v_mfma_f32_16x16x32_bf16 v[120:123], v[236:239], a[112:115], v[120:123]
    s_add_u32 m0, s48, 4096
    s_add_u32 s47, s85, 0
    buffer_load_dwordx4 v6, s[24:27], s47 offen lds
    buffer_load_dwordx4 v7, s[24:27], s47 offen offset:1024 lds
    s_waitcnt lgkmcnt(4)
    v_mfma_f32_16x16x32_bf16 v[44:47], v[240:243], a[132:135], v[44:47]
    s_waitcnt vmcnt(11)
    ds_read_b64_tr_b16 v[130:131], v10 offset:16384
    v_mfma_f32_16x16x32_bf16 v[64:67], v[244:247], a[132:135], v[64:67]
    s_barrier
    ds_read_b64_tr_b16 v[134:135], v11 offset:16384
    v_mfma_f32_16x16x32_bf16 v[84:87], v[248:251], a[132:135], v[84:87]
    ds_read_b128 a[96:99], v34
    ds_read_b64_tr_b16 v[138:139], v12 offset:16384
    v_mfma_f32_16x16x32_bf16 v[104:107], v[252:255], a[132:135], v[104:107]
    ds_read_b128 a[100:103], v34 offset:2048
    ds_read_b64_tr_b16 v[142:143], v13 offset:16384
    v_mfma_f32_16x16x32_bf16 v[48:51], v[240:243], a[136:139], v[48:51]
    ds_read_b128 a[104:107], v34 offset:4096
    v_mfma_f32_16x16x32_bf16 v[68:71], v[244:247], a[136:139], v[68:71]
    s_add_u32 m0, s48, 6144
    s_add_u32 s47, s85, 32768
    buffer_load_dwordx4 v6, s[24:27], s47 offen lds
    buffer_load_dwordx4 v7, s[24:27], s47 offen offset:1024 lds
    v_mfma_f32_16x16x32_bf16 v[88:91], v[248:251], a[136:139], v[88:91]
    ds_read_b128 a[108:111], v34 offset:6144
    s_waitcnt vmcnt(11)
    v_mfma_f32_16x16x32_bf16 v[108:111], v[252:255], a[136:139], v[108:111]
    ds_read_b128 a[112:115], v34 offset:8192
    ds_read_b64_tr_b16 v[144:145], v10
    v_mfma_f32_16x16x32_bf16 v[52:55], v[240:243], a[140:143], v[52:55]
    ds_read_b64_tr_b16 v[148:149], v11
    ds_read_b64_tr_b16 v[152:153], v12
    v_mfma_f32_16x16x32_bf16 v[72:75], v[244:247], a[140:143], v[72:75]
    ds_read_b64_tr_b16 v[156:157], v13
    v_mfma_f32_16x16x32_bf16 v[92:95], v[248:251], a[140:143], v[92:95]
    v_mfma_f32_16x16x32_bf16 v[112:115], v[252:255], a[140:143], v[112:115]
    v_mfma_f32_16x16x32_bf16 v[56:59], v[240:243], a[144:147], v[56:59]
    s_add_u32 m0, s48, 8192
    s_add_u32 s47, s85, 262144
    buffer_load_dwordx4 v6, s[24:27], s47 offen lds
    buffer_load_dwordx4 v7, s[24:27], s47 offen offset:1024 lds
    v_mfma_f32_16x16x32_bf16 v[76:79], v[244:247], a[144:147], v[76:79]
    s_waitcnt vmcnt(11)
    ds_read_b64_tr_b16 v[146:147], v10 offset:2048
    v_mfma_f32_16x16x32_bf16 v[96:99], v[248:251], a[144:147], v[96:99]
    ds_read_b64_tr_b16 v[150:151], v11 offset:2048
    ds_read_b64_tr_b16 v[154:155], v12 offset:2048
    v_mfma_f32_16x16x32_bf16 v[116:119], v[252:255], a[144:147], v[116:119]
    ds_read_b64_tr_b16 v[158:159], v13 offset:2048
    v_mfma_f32_16x16x32_bf16 v[60:63], v[240:243], a[148:151], v[60:63]
    v_mfma_f32_16x16x32_bf16 v[80:83], v[244:247], a[148:151], v[80:83]
    v_mfma_f32_16x16x32_bf16 v[100:103], v[248:251], a[148:151], v[100:103]
    v_mfma_f32_16x16x32_bf16 v[120:123], v[252:255], a[148:151], v[120:123]
    s_waitcnt lgkmcnt(11)
    s_waitcnt lgkmcnt(8)
    v_mfma_f32_16x16x32_bf16 v[44:47], v[128:131], a[96:99], v[44:47]
    v_mfma_f32_16x16x32_bf16 v[64:67], v[132:135], a[96:99], v[64:67]
    ds_read_b128 a[132:135], v35
    v_mfma_f32_16x16x32_bf16 v[84:87], v[136:139], a[96:99], v[84:87]
    ds_read_b128 a[136:139], v35 offset:2048
    v_mfma_f32_16x16x32_bf16 v[104:107], v[140:143], a[96:99], v[104:107]
    ds_read_b128 a[140:143], v35 offset:4096
    v_mfma_f32_16x16x32_bf16 v[48:51], v[128:131], a[100:103], v[48:51]
    v_mfma_f32_16x16x32_bf16 v[68:71], v[132:135], a[100:103], v[68:71]
    ds_read_b128 a[144:147], v35 offset:6144
    v_mfma_f32_16x16x32_bf16 v[88:91], v[136:139], a[100:103], v[88:91]
    ds_read_b128 a[148:151], v35 offset:8192
    v_mfma_f32_16x16x32_bf16 v[108:111], v[140:143], a[100:103], v[108:111]
    v_mfma_f32_16x16x32_bf16 v[52:55], v[128:131], a[104:107], v[52:55]
    v_mfma_f32_16x16x32_bf16 v[72:75], v[132:135], a[104:107], v[72:75]
    s_add_u32 m0, s48, 10240
    s_add_u32 s47, s85, 294912
    buffer_load_dwordx4 v6, s[24:27], s47 offen lds
    buffer_load_dwordx4 v7, s[24:27], s47 offen offset:1024 lds
    v_mfma_f32_16x16x32_bf16 v[92:95], v[136:139], a[104:107], v[92:95]
    s_add_u32 m0, s48, 12288
    s_add_u32 s47, s86, 0
    buffer_load_dwordx4 v6, s[24:27], s47 offen lds
    buffer_load_dwordx4 v7, s[24:27], s47 offen offset:1024 lds
    v_mfma_f32_16x16x32_bf16 v[112:115], v[140:143], a[104:107], v[112:115]
    s_waitcnt vmcnt(10)
    v_mfma_f32_16x16x32_bf16 v[56:59], v[128:131], a[108:111], v[56:59]
    v_mfma_f32_16x16x32_bf16 v[76:79], v[132:135], a[108:111], v[76:79]
    v_mfma_f32_16x16x32_bf16 v[96:99], v[136:139], a[108:111], v[96:99]
    v_mfma_f32_16x16x32_bf16 v[116:119], v[140:143], a[108:111], v[116:119]
    s_add_u32 m0, s48, 14336
    s_add_u32 s47, s86, 32768
    buffer_load_dwordx4 v6, s[24:27], s47 offen lds
    buffer_load_dwordx4 v7, s[24:27], s47 offen offset:1024 lds
    v_mfma_f32_16x16x32_bf16 v[60:63], v[128:131], a[112:115], v[60:63]
    s_waitcnt vmcnt(10)
    ds_read_b64_tr_b16 v[160:161], v10 offset:4096
    v_mfma_f32_16x16x32_bf16 v[80:83], v[132:135], a[112:115], v[80:83]
    ds_read_b64_tr_b16 v[164:165], v11 offset:4096
    ds_read_b64_tr_b16 v[168:169], v12 offset:4096
    v_mfma_f32_16x16x32_bf16 v[100:103], v[136:139], a[112:115], v[100:103]
    ds_read_b64_tr_b16 v[172:173], v13 offset:4096
    v_mfma_f32_16x16x32_bf16 v[120:123], v[140:143], a[112:115], v[120:123]
    s_waitcnt lgkmcnt(9)
    s_waitcnt lgkmcnt(4)
    v_mfma_f32_16x16x32_bf16 v[44:47], v[144:147], a[132:135], v[44:47]
    v_mfma_f32_16x16x32_bf16 v[64:67], v[148:151], a[132:135], v[64:67]
    ds_read_b128 a[96:99], v34 offset:10240
    s_add_u32 m0, s48, 16384
    s_add_u32 s47, s86, 262144
    buffer_load_dwordx4 v6, s[24:27], s47 offen lds
    buffer_load_dwordx4 v7, s[24:27], s47 offen offset:1024 lds
    v_mfma_f32_16x16x32_bf16 v[84:87], v[152:155], a[132:135], v[84:87]
    ds_read_b128 a[100:103], v34 offset:12288
    s_waitcnt vmcnt(10)
    v_mfma_f32_16x16x32_bf16 v[104:107], v[156:159], a[132:135], v[104:107]
    ds_read_b128 a[104:107], v34 offset:14336
    ds_read_b64_tr_b16 v[162:163], v10 offset:6144
    v_mfma_f32_16x16x32_bf16 v[48:51], v[144:147], a[136:139], v[48:51]
    ds_read_b64_tr_b16 v[166:167], v11 offset:6144
    ds_read_b64_tr_b16 v[170:171], v12 offset:6144
    v_mfma_f32_16x16x32_bf16 v[68:71], v[148:151], a[136:139], v[68:71]
    ds_read_b128 a[108:111], v34 offset:16384
    ds_read_b64_tr_b16 v[174:175], v13 offset:6144
    v_mfma_f32_16x16x32_bf16 v[88:91], v[152:155], a[136:139], v[88:91]
    ds_read_b128 a[112:115], v34 offset:18432
    v_mfma_f32_16x16x32_bf16 v[108:111], v[156:159], a[136:139], v[108:111]
    s_add_u32 m0, s48, 0
    s_add_u32 s47, s86, 294912
    buffer_load_dwordx4 v6, s[24:27], s47 offen lds
    buffer_load_dwordx4 v7, s[24:27], s47 offen offset:1024 lds
    v_mfma_f32_16x16x32_bf16 v[52:55], v[144:147], a[140:143], v[52:55]
    s_waitcnt vmcnt(10)
    ds_read_b64_tr_b16 v[176:177], v10 offset:8192
    v_mfma_f32_16x16x32_bf16 v[72:75], v[148:151], a[140:143], v[72:75]
    ds_read_b64_tr_b16 v[180:181], v11 offset:8192
    ds_read_b64_tr_b16 v[184:185], v12 offset:8192
    v_mfma_f32_16x16x32_bf16 v[92:95], v[152:155], a[140:143], v[92:95]
    ds_read_b64_tr_b16 v[188:189], v13 offset:8192
    v_mfma_f32_16x16x32_bf16 v[112:115], v[156:159], a[140:143], v[112:115]
    v_mfma_f32_16x16x32_bf16 v[56:59], v[144:147], a[144:147], v[56:59]
    v_mfma_f32_16x16x32_bf16 v[76:79], v[148:151], a[144:147], v[76:79]
    v_mfma_f32_16x16x32_bf16 v[96:99], v[152:155], a[144:147], v[96:99]
    v_mfma_f32_16x16x32_bf16 v[116:119], v[156:159], a[144:147], v[116:119]
    v_mfma_f32_16x16x32_bf16 v[60:63], v[144:147], a[148:151], v[60:63]
    v_mfma_f32_16x16x32_bf16 v[80:83], v[148:151], a[148:151], v[80:83]
    v_mfma_f32_16x16x32_bf16 v[100:103], v[152:155], a[148:151], v[100:103]
    v_mfma_f32_16x16x32_bf16 v[120:123], v[156:159], a[148:151], v[120:123]
    s_waitcnt lgkmcnt(5)
    s_waitcnt lgkmcnt(4)
    v_mfma_f32_16x16x32_bf16 v[44:47], v[160:163], a[96:99], v[44:47]
    v_mfma_f32_16x16x32_bf16 v[64:67], v[164:167], a[96:99], v[64:67]
    ds_read_b128 a[132:135], v35 offset:10240
    v_mfma_f32_16x16x32_bf16 v[84:87], v[168:171], a[96:99], v[84:87]
    ds_read_b128 a[136:139], v35 offset:12288
    s_add_u32 m0, s48, 2048
    s_mov_b32 s47, 0
    buffer_load_dwordx4 v4, s[28:31], s47 offen nt lds
    buffer_load_dwordx4 v5, s[28:31], s47 offen offset:1024 nt lds
    v_mfma_f32_16x16x32_bf16 v[104:107], v[172:175], a[96:99], v[104:107]
    ds_read_b128 a[140:143], v35 offset:14336
    s_waitcnt vmcnt(10)
    v_mfma_f32_16x16x32_bf16 v[48:51], v[160:163], a[100:103], v[48:51]
    ds_read_b64_tr_b16 v[178:179], v10 offset:10240
    ds_read_b64_tr_b16 v[182:183], v11 offset:10240
    v_mfma_f32_16x16x32_bf16 v[68:71], v[164:167], a[100:103], v[68:71]
    ds_read_b128 a[144:147], v35 offset:16384
    ds_read_b64_tr_b16 v[186:187], v12 offset:10240
    v_mfma_f32_16x16x32_bf16 v[88:91], v[168:171], a[100:103], v[88:91]
    ds_read_b128 a[148:151], v35 offset:18432
    ds_read_b64_tr_b16 v[190:191], v13 offset:10240
    v_mfma_f32_16x16x32_bf16 v[108:111], v[172:175], a[100:103], v[108:111]
    v_mfma_f32_16x16x32_bf16 v[52:55], v[160:163], a[104:107], v[52:55]
    s_add_u32 m0, s48, 4096
    s_mov_b32 s47, 128
    buffer_load_dwordx4 v4, s[28:31], s47 offen nt lds
    buffer_load_dwordx4 v5, s[28:31], s47 offen offset:1024 nt lds
    v_mfma_f32_16x16x32_bf16 v[72:75], v[164:167], a[104:107], v[72:75]
    s_waitcnt vmcnt(10)
    ds_read_b64_tr_b16 v[192:193], v10 offset:12288
    v_mfma_f32_16x16x32_bf16 v[92:95], v[168:171], a[104:107], v[92:95]
    ds_read_b64_tr_b16 v[196:197], v11 offset:12288
    ds_read_b64_tr_b16 v[200:201], v12 offset:12288
    v_mfma_f32_16x16x32_bf16 v[112:115], v[172:175], a[104:107], v[112:115]
    ds_read_b64_tr_b16 v[204:205], v13 offset:12288
    v_mfma_f32_16x16x32_bf16 v[56:59], v[160:163], a[108:111], v[56:59]
    v_mfma_f32_16x16x32_bf16 v[76:79], v[164:167], a[108:111], v[76:79]
    v_mfma_f32_16x16x32_bf16 v[96:99], v[168:171], a[108:111], v[96:99]
    s_add_u32 m0, s48, 6144
    s_mov_b32 s47, 256
    buffer_load_dwordx4 v4, s[28:31], s47 offen nt lds
    buffer_load_dwordx4 v5, s[28:31], s47 offen offset:1024 nt lds
    v_mfma_f32_16x16x32_bf16 v[116:119], v[172:175], a[108:111], v[116:119]
    s_waitcnt vmcnt(10)
    ds_read_b64_tr_b16 v[194:195], v10 offset:14336
    v_mfma_f32_16x16x32_bf16 v[60:63], v[160:163], a[112:115], v[60:63]
    ds_read_b64_tr_b16 v[198:199], v11 offset:14336
    ds_read_b64_tr_b16 v[202:203], v12 offset:14336
    v_mfma_f32_16x16x32_bf16 v[80:83], v[164:167], a[112:115], v[80:83]
    ds_read_b64_tr_b16 v[206:207], v13 offset:14336
    v_mfma_f32_16x16x32_bf16 v[100:103], v[168:171], a[112:115], v[100:103]
    v_mfma_f32_16x16x32_bf16 v[120:123], v[172:175], a[112:115], v[120:123]
    s_waitcnt lgkmcnt(8)
    v_mfma_f32_16x16x32_bf16 v[44:47], v[176:179], a[132:135], v[44:47]
    v_mfma_f32_16x16x32_bf16 v[64:67], v[180:183], a[132:135], v[64:67]
    s_barrier
    s_add_u32 m0, s48, 8192
    s_mov_b32 s47, 384
    buffer_load_dwordx4 v4, s[28:31], s47 offen nt lds
    buffer_load_dwordx4 v5, s[28:31], s47 offen offset:1024 nt lds
    v_mfma_f32_16x16x32_bf16 v[84:87], v[184:187], a[132:135], v[84:87]
    ds_read_b128 a[96:99], v34 offset:20480
    s_waitcnt vmcnt(10)
    v_mfma_f32_16x16x32_bf16 v[104:107], v[188:191], a[132:135], v[104:107]
    ds_read_b128 a[100:103], v34 offset:22528
    ds_read_b64_tr_b16 v[208:209], v10 offset:16384
    v_mfma_f32_16x16x32_bf16 v[48:51], v[176:179], a[136:139], v[48:51]
    ds_read_b128 a[104:107], v34 offset:24576
    ds_read_b64_tr_b16 v[212:213], v11 offset:16384
    v_mfma_f32_16x16x32_bf16 v[68:71], v[180:183], a[136:139], v[68:71]
    ds_read_b64_tr_b16 v[216:217], v12 offset:16384
    ds_read_b64_tr_b16 v[220:221], v13 offset:16384
    v_mfma_f32_16x16x32_bf16 v[88:91], v[184:187], a[136:139], v[88:91]
    ds_read_b128 a[108:111], v34 offset:26624
    v_mfma_f32_16x16x32_bf16 v[108:111], v[188:191], a[136:139], v[108:111]
    ds_read_b128 a[112:115], v34 offset:28672
    s_add_u32 m0, s48, 10240
    s_mov_b32 s47, 8192
    buffer_load_dwordx4 v4, s[28:31], s47 offen nt lds
    buffer_load_dwordx4 v5, s[28:31], s47 offen offset:1024 nt lds
    v_mfma_f32_16x16x32_bf16 v[52:55], v[176:179], a[140:143], v[52:55]
    s_waitcnt vmcnt(10)
    ds_read_b64_tr_b16 v[210:211], v10
    v_mfma_f32_16x16x32_bf16 v[72:75], v[180:183], a[140:143], v[72:75]
    ds_read_b64_tr_b16 v[214:215], v11
    ds_read_b64_tr_b16 v[218:219], v12
    v_mfma_f32_16x16x32_bf16 v[92:95], v[184:187], a[140:143], v[92:95]
    ds_read_b64_tr_b16 v[222:223], v13
    v_mfma_f32_16x16x32_bf16 v[112:115], v[188:191], a[140:143], v[112:115]
    v_mfma_f32_16x16x32_bf16 v[56:59], v[176:179], a[144:147], v[56:59]
    v_mfma_f32_16x16x32_bf16 v[76:79], v[180:183], a[144:147], v[76:79]
    v_mfma_f32_16x16x32_bf16 v[96:99], v[184:187], a[144:147], v[96:99]
    v_mfma_f32_16x16x32_bf16 v[116:119], v[188:191], a[144:147], v[116:119]
    v_mfma_f32_16x16x32_bf16 v[60:63], v[176:179], a[148:151], v[60:63]
    v_mfma_f32_16x16x32_bf16 v[80:83], v[180:183], a[148:151], v[80:83]
    v_mfma_f32_16x16x32_bf16 v[100:103], v[184:187], a[148:151], v[100:103]
    v_mfma_f32_16x16x32_bf16 v[120:123], v[188:191], a[148:151], v[120:123]
    s_waitcnt lgkmcnt(13)
    s_waitcnt lgkmcnt(4)
    v_mfma_f32_16x16x32_bf16 v[44:47], v[192:195], a[96:99], v[44:47]
    v_mfma_f32_16x16x32_bf16 v[64:67], v[196:199], a[96:99], v[64:67]
    ds_read_b128 a[132:135], v35 offset:20480
    v_mfma_f32_16x16x32_bf16 v[84:87], v[200:203], a[96:99], v[84:87]
    ds_read_b128 a[136:139], v35 offset:22528
    v_mfma_f32_16x16x32_bf16 v[104:107], v[204:207], a[96:99], v[104:107]
    ds_read_b128 a[140:143], v35 offset:24576
    v_mfma_f32_16x16x32_bf16 v[48:51], v[192:195], a[100:103], v[48:51]
    v_mfma_f32_16x16x32_bf16 v[68:71], v[196:199], a[100:103], v[68:71]
    ds_read_b128 a[144:147], v35 offset:26624
    v_mfma_f32_16x16x32_bf16 v[88:91], v[200:203], a[100:103], v[88:91]
    ds_read_b128 a[148:151], v35 offset:28672
    v_mfma_f32_16x16x32_bf16 v[108:111], v[204:207], a[100:103], v[108:111]
    v_mfma_f32_16x16x32_bf16 v[52:55], v[192:195], a[104:107], v[52:55]
    v_mfma_f32_16x16x32_bf16 v[72:75], v[196:199], a[104:107], v[72:75]
    v_mfma_f32_16x16x32_bf16 v[92:95], v[200:203], a[104:107], v[92:95]
    v_mfma_f32_16x16x32_bf16 v[112:115], v[204:207], a[104:107], v[112:115]
    v_mfma_f32_16x16x32_bf16 v[56:59], v[192:195], a[108:111], v[56:59]
    v_mfma_f32_16x16x32_bf16 v[76:79], v[196:199], a[108:111], v[76:79]
    v_mfma_f32_16x16x32_bf16 v[96:99], v[200:203], a[108:111], v[96:99]
    v_mfma_f32_16x16x32_bf16 v[116:119], v[204:207], a[108:111], v[116:119]
    v_mfma_f32_16x16x32_bf16 v[60:63], v[192:195], a[112:115], v[60:63]
    v_mfma_f32_16x16x32_bf16 v[80:83], v[196:199], a[112:115], v[80:83]
    v_mfma_f32_16x16x32_bf16 v[100:103], v[200:203], a[112:115], v[100:103]
    v_mfma_f32_16x16x32_bf16 v[120:123], v[204:207], a[112:115], v[120:123]
    s_waitcnt lgkmcnt(5)
    s_waitcnt lgkmcnt(0)
    v_mfma_f32_16x16x32_bf16 v[44:47], v[208:211], a[132:135], v[44:47]
    v_mfma_f32_16x16x32_bf16 v[64:67], v[212:215], a[132:135], v[64:67]
    v_mfma_f32_16x16x32_bf16 v[84:87], v[216:219], a[132:135], v[84:87]
    v_mfma_f32_16x16x32_bf16 v[104:107], v[220:223], a[132:135], v[104:107]
    v_mfma_f32_16x16x32_bf16 v[48:51], v[208:211], a[136:139], v[48:51]
    v_mfma_f32_16x16x32_bf16 v[68:71], v[212:215], a[136:139], v[68:71]
    v_mfma_f32_16x16x32_bf16 v[88:91], v[216:219], a[136:139], v[88:91]
    s_add_u32 m0, s48, 12288
    s_mov_b32 s47, 8320
    buffer_load_dwordx4 v4, s[28:31], s47 offen nt lds
    buffer_load_dwordx4 v5, s[28:31], s47 offen offset:1024 nt lds
    v_mfma_f32_16x16x32_bf16 v[108:111], v[220:223], a[136:139], v[108:111]
    v_mfma_f32_16x16x32_bf16 v[52:55], v[208:211], a[140:143], v[52:55]
    v_mfma_f32_16x16x32_bf16 v[72:75], v[212:215], a[140:143], v[72:75]
    v_mfma_f32_16x16x32_bf16 v[92:95], v[216:219], a[140:143], v[92:95]
    v_mfma_f32_16x16x32_bf16 v[112:115], v[220:223], a[140:143], v[112:115]
    v_mfma_f32_16x16x32_bf16 v[56:59], v[208:211], a[144:147], v[56:59]
    v_mfma_f32_16x16x32_bf16 v[76:79], v[212:215], a[144:147], v[76:79]
    v_mfma_f32_16x16x32_bf16 v[96:99], v[216:219], a[144:147], v[96:99]
    v_mfma_f32_16x16x32_bf16 v[116:119], v[220:223], a[144:147], v[116:119]
    v_mfma_f32_16x16x32_bf16 v[60:63], v[208:211], a[148:151], v[60:63]
    v_mfma_f32_16x16x32_bf16 v[80:83], v[212:215], a[148:151], v[80:83]
    v_mfma_f32_16x16x32_bf16 v[100:103], v[216:219], a[148:151], v[100:103]
    v_mfma_f32_16x16x32_bf16 v[120:123], v[220:223], a[148:151], v[120:123]
    v_cvt_pk_bf16_f32 v44, v44, v45
    v_cvt_pk_bf16_f32 v45, v46, v47
    ds_write_b64 v18, v[44:45]
    s_add_u32 m0, s48, 14336
    s_mov_b32 s47, 8448
    buffer_load_dwordx4 v4, s[28:31], s47 offen nt lds
    buffer_load_dwordx4 v5, s[28:31], s47 offen offset:1024 nt lds
    v_cvt_pk_bf16_f32 v64, v64, v65
    v_cvt_pk_bf16_f32 v65, v66, v67
    ds_write_b64 v18, v[64:65] offset:512
    v_cvt_pk_bf16_f32 v84, v84, v85
    v_cvt_pk_bf16_f32 v85, v86, v87
    ds_write_b64 v18, v[84:85] offset:5120
    v_cvt_pk_bf16_f32 v104, v104, v105
    v_cvt_pk_bf16_f32 v105, v106, v107
    ds_write_b64 v18, v[104:105] offset:5632
    v_cvt_pk_bf16_f32 v48, v48, v49
    v_cvt_pk_bf16_f32 v49, v50, v51
    ds_write_b64 v18, v[48:49] offset:1024
    v_cvt_pk_bf16_f32 v68, v68, v69
    v_cvt_pk_bf16_f32 v69, v70, v71
    ds_write_b64 v18, v[68:69] offset:1536
    v_cvt_pk_bf16_f32 v88, v88, v89
    v_cvt_pk_bf16_f32 v89, v90, v91
    ds_write_b64 v18, v[88:89] offset:6144
    v_cvt_pk_bf16_f32 v108, v108, v109
    v_cvt_pk_bf16_f32 v109, v110, v111
    ds_write_b64 v18, v[108:109] offset:6656
    v_cvt_pk_bf16_f32 v52, v52, v53
    v_cvt_pk_bf16_f32 v53, v54, v55
    ds_write_b64 v18, v[52:53] offset:2048
    v_cvt_pk_bf16_f32 v72, v72, v73
    v_cvt_pk_bf16_f32 v73, v74, v75
    ds_write_b64 v18, v[72:73] offset:2560
    v_cvt_pk_bf16_f32 v92, v92, v93
    v_cvt_pk_bf16_f32 v93, v94, v95
    ds_write_b64 v18, v[92:93] offset:7168
    v_cvt_pk_bf16_f32 v112, v112, v113
    v_cvt_pk_bf16_f32 v113, v114, v115
    ds_write_b64 v18, v[112:113] offset:7680
    v_cvt_pk_bf16_f32 v56, v56, v57
    v_cvt_pk_bf16_f32 v57, v58, v59
    ds_write_b64 v18, v[56:57] offset:3072
    v_cvt_pk_bf16_f32 v76, v76, v77
    v_cvt_pk_bf16_f32 v77, v78, v79
    ds_write_b64 v18, v[76:77] offset:3584
    v_cvt_pk_bf16_f32 v96, v96, v97
    v_cvt_pk_bf16_f32 v97, v98, v99
    ds_write_b64 v18, v[96:97] offset:8192
    v_cvt_pk_bf16_f32 v116, v116, v117
    v_cvt_pk_bf16_f32 v117, v118, v119
    ds_write_b64 v18, v[116:117] offset:8704
    v_cvt_pk_bf16_f32 v60, v60, v61
    v_cvt_pk_bf16_f32 v61, v62, v63
    ds_write_b64 v18, v[60:61] offset:4096
    v_cvt_pk_bf16_f32 v80, v80, v81
    v_cvt_pk_bf16_f32 v81, v82, v83
    ds_write_b64 v18, v[80:81] offset:4608
    v_cvt_pk_bf16_f32 v100, v100, v101
    v_cvt_pk_bf16_f32 v101, v102, v103
    ds_write_b64 v18, v[100:101] offset:9216
    s_add_u32 m0, s48, 16384
    s_mov_b32 s47, 8576
    buffer_load_dwordx4 v4, s[28:31], s47 offen nt lds
    buffer_load_dwordx4 v5, s[28:31], s47 offen offset:1024 nt lds
    v_cvt_pk_bf16_f32 v120, v120, v121
    v_cvt_pk_bf16_f32 v121, v122, v123
    ds_write_b64 v18, v[120:121] offset:9728
    s_waitcnt lgkmcnt(0)
    s_barrier
    ds_read_b128 a[0:3], v16
    ds_read_b128 a[4:7], v16 offset:1024
    ds_read_b128 a[8:11], v16 offset:2048
    ds_read_b128 a[12:15], v16 offset:3072
    ds_read_b128 a[16:19], v16 offset:4096
    s_waitcnt vmcnt(14)
    ds_read_b128 a[20:23], v16 offset:5120
    ds_read_b128 a[24:27], v16 offset:6144
    ds_read_b128 a[28:31], v16 offset:7168
    ds_read_b128 a[32:35], v16 offset:8192
    ds_read_b128 a[36:39], v16 offset:9216
    ds_read_b128 v[64:67], v14 offset:2048
    ds_read_b128 a[40:43], v16 offset:10240
    ds_read_b128 a[44:47], v16 offset:11264
    ds_read_b128 a[48:51], v16 offset:12288
    ds_read_b128 a[52:55], v16 offset:13312
    ds_read_b128 a[56:59], v16 offset:14336
    ds_read_b128 v[68:71], v15 offset:2048
    ds_read_b128 a[60:63], v16 offset:15360
    ds_read_b128 a[64:67], v16 offset:16384
    ds_read_b128 a[68:71], v16 offset:17408
    ds_read_b128 a[72:75], v16 offset:18432
    ds_read_b128 a[76:79], v16 offset:19456
    s_add_u32 m0, s48, 0
    s_mov_b32 s47, 16384
    buffer_load_dwordx4 v4, s[28:31], s47 offen nt lds
    buffer_load_dwordx4 v5, s[28:31], s47 offen offset:1024 nt lds
    ds_read_b128 a[80:83], v16 offset:20480
    ds_read_b128 a[84:87], v16 offset:21504
    ds_read_b128 a[88:91], v16 offset:22528
    ds_read_b128 a[92:95], v16 offset:23552
    ds_read_b128 a[96:99], v16 offset:24576
    s_waitcnt vmcnt(14)
    ds_read_b128 a[100:103], v16 offset:25600
    ds_read_b128 a[104:107], v16 offset:26624
    ds_read_b128 a[108:111], v16 offset:27648
    ds_read_b128 a[112:115], v16 offset:28672
    ds_read_b128 a[116:119], v16 offset:29696
    ds_read_b128 v[72:75], v14 offset:4096
    ds_read_b128 a[120:123], v16 offset:30720
    ds_read_b128 a[124:127], v16 offset:31744
    ds_read_b128 a[128:131], v16 offset:32768
    ds_read_b128 a[132:135], v16 offset:33792
    ds_read_b128 a[136:139], v16 offset:34816
    ds_read_b128 v[76:79], v15 offset:4096
    ds_read_b128 a[140:143], v16 offset:35840
    ds_read_b128 a[144:147], v16 offset:36864
    ds_read_b128 a[148:151], v16 offset:37888
    ds_read_b128 a[152:155], v16 offset:38912
    ds_read_b128 a[156:159], v16 offset:39936
    s_waitcnt lgkmcnt(15)
    s_add_u32 m0, s48, 2048
    s_mov_b32 s47, 16512
    buffer_load_dwordx4 v4, s[28:31], s47 offen nt lds
    buffer_load_dwordx4 v5, s[28:31], s47 offen offset:1024 nt lds
    v_mfma_f32_16x16x32_bf16 v[44:47], v[64:67], a[0:3], 0
    s_waitcnt vmcnt(14)
    ds_read_b128 v[80:83], v14 offset:6144
    v_mfma_f32_16x16x32_bf16 v[48:51], v[64:67], a[4:7], 0
    ds_read_b128 v[84:87], v15 offset:6144
    v_mfma_f32_16x16x32_bf16 v[52:55], v[64:67], a[8:11], 0
    s_waitcnt vmcnt(12)
    ds_read_b128 v[88:91], v14 offset:8192
    v_mfma_f32_16x16x32_bf16 v[56:59], v[64:67], a[12:15], 0
    ds_read_b128 v[92:95], v15 offset:8192
    v_mfma_f32_16x16x32_bf16 v[60:63], v[64:67], a[16:19], 0
    v_mfma_f32_16x16x32_bf16 v[44:47], v[68:71], a[20:23], v[44:47]
    v_mfma_f32_16x16x32_bf16 v[48:51], v[68:71], a[24:27], v[48:51]
    v_mfma_f32_16x16x32_bf16 v[52:55], v[68:71], a[28:31], v[52:55]
    s_waitcnt lgkmcnt(9)
    s_add_u32 m0, s48, 4096
    s_mov_b32 s47, 16640
    buffer_load_dwordx4 v4, s[28:31], s47 offen nt lds
    buffer_load_dwordx4 v5, s[28:31], s47 offen offset:1024 nt lds
    v_mfma_f32_16x16x32_bf16 v[56:59], v[68:71], a[32:35], v[56:59]
    v_mfma_f32_16x16x32_bf16 v[60:63], v[68:71], a[36:39], v[60:63]
    v_mfma_f32_16x16x32_bf16 v[44:47], v[72:75], a[40:43], v[44:47]
    v_mfma_f32_16x16x32_bf16 v[48:51], v[72:75], a[44:47], v[48:51]
    v_mfma_f32_16x16x32_bf16 v[52:55], v[72:75], a[48:51], v[52:55]
    v_mfma_f32_16x16x32_bf16 v[56:59], v[72:75], a[52:55], v[56:59]
    v_mfma_f32_16x16x32_bf16 v[60:63], v[72:75], a[56:59], v[60:63]
    v_mfma_f32_16x16x32_bf16 v[44:47], v[76:79], a[60:63], v[44:47]
    v_mfma_f32_16x16x32_bf16 v[48:51], v[76:79], a[64:67], v[48:51]
    s_waitcnt vmcnt(12)
    ds_read_b128 v[96:99], v14 offset:10240
    v_mfma_f32_16x16x32_bf16 v[52:55], v[76:79], a[68:71], v[52:55]
    ds_read_b128 v[100:103], v15 offset:10240
    v_mfma_f32_16x16x32_bf16 v[56:59], v[76:79], a[72:75], v[56:59]
    v_mfma_f32_16x16x32_bf16 v[60:63], v[76:79], a[76:79], v[60:63]
    s_waitcnt lgkmcnt(4)
    v_mfma_f32_16x16x32_bf16 v[44:47], v[80:83], a[80:83], v[44:47]
    v_mfma_f32_16x16x32_bf16 v[48:51], v[80:83], a[84:87], v[48:51]
    s_add_u32 m0, s48, 6144
    s_mov_b32 s47, 16768
    buffer_load_dwordx4 v4, s[28:31], s47 offen nt lds
    buffer_load_dwordx4 v5, s[28:31], s47 offen offset:1024 nt lds
    v_mfma_f32_16x16x32_bf16 v[52:55], v[80:83], a[88:91], v[52:55]
    v_mfma_f32_16x16x32_bf16 v[56:59], v[80:83], a[92:95], v[56:59]
    v_mfma_f32_16x16x32_bf16 v[60:63], v[80:83], a[96:99], v[60:63]
    v_mfma_f32_16x16x32_bf16 v[44:47], v[84:87], a[100:103], v[44:47]
    v_mfma_f32_16x16x32_bf16 v[48:51], v[84:87], a[104:107], v[48:51]
    v_mfma_f32_16x16x32_bf16 v[52:55], v[84:87], a[108:111], v[52:55]
    v_mfma_f32_16x16x32_bf16 v[56:59], v[84:87], a[112:115], v[56:59]
    v_mfma_f32_16x16x32_bf16 v[60:63], v[84:87], a[116:119], v[60:63]
    s_waitcnt lgkmcnt(2)
    v_mfma_f32_16x16x32_bf16 v[44:47], v[88:91], a[120:123], v[44:47]
    s_waitcnt vmcnt(12)
    ds_read_b128 v[104:107], v14 offset:12288
    v_mfma_f32_16x16x32_bf16 v[48:51], v[88:91], a[124:127], v[48:51]
    ds_read_b128 v[108:111], v15 offset:12288
    v_mfma_f32_16x16x32_bf16 v[52:55], v[88:91], a[128:131], v[52:55]
    v_mfma_f32_16x16x32_bf16 v[56:59], v[88:91], a[132:135], v[56:59]
    v_mfma_f32_16x16x32_bf16 v[60:63], v[88:91], a[136:139], v[60:63]
    v_mfma_f32_16x16x32_bf16 v[44:47], v[92:95], a[140:143], v[44:47]
    s_add_u32 m0, s48, 8192
    s_mov_b32 s47, 24576
    buffer_load_dwordx4 v4, s[28:31], s47 offen nt lds
    buffer_load_dwordx4 v5, s[28:31], s47 offen offset:1024 nt lds
    v_mfma_f32_16x16x32_bf16 v[48:51], v[92:95], a[144:147], v[48:51]
    v_mfma_f32_16x16x32_bf16 v[52:55], v[92:95], a[148:151], v[52:55]
    v_mfma_f32_16x16x32_bf16 v[56:59], v[92:95], a[152:155], v[56:59]
    v_mfma_f32_16x16x32_bf16 v[60:63], v[92:95], a[156:159], v[60:63]
    s_waitcnt lgkmcnt(2)
    v_mfma_f32_16x16x32_bf16 v[64:67], v[96:99], a[0:3], 0
    v_mfma_f32_16x16x32_bf16 v[68:71], v[96:99], a[4:7], 0
    v_mfma_f32_16x16x32_bf16 v[72:75], v[96:99], a[8:11], 0
    v_mfma_f32_16x16x32_bf16 v[76:79], v[96:99], a[12:15], 0
    v_mfma_f32_16x16x32_bf16 v[80:83], v[96:99], a[16:19], 0
    s_waitcnt vmcnt(12)
    ds_read_b128 v[112:115], v14 offset:14336
    v_mfma_f32_16x16x32_bf16 v[64:67], v[100:103], a[20:23], v[64:67]
    ds_read_b128 v[116:119], v15 offset:14336
    v_mfma_f32_16x16x32_bf16 v[68:71], v[100:103], a[24:27], v[68:71]
    v_mfma_f32_16x16x32_bf16 v[72:75], v[100:103], a[28:31], v[72:75]
    v_mfma_f32_16x16x32_bf16 v[76:79], v[100:103], a[32:35], v[76:79]
    v_mfma_f32_16x16x32_bf16 v[80:83], v[100:103], a[36:39], v[80:83]
    v_max3_f32 v22, v44, v45, v46
    s_add_u32 m0, s48, 10240
    s_mov_b32 s47, 24704
    buffer_load_dwordx4 v4, s[28:31], s47 offen nt lds
    buffer_load_dwordx4 v5, s[28:31], s47 offen offset:1024 nt lds
    s_waitcnt lgkmcnt(2)
    v_mfma_f32_16x16x32_bf16 v[64:67], v[104:107], a[40:43], v[64:67]
    v_mfma_f32_16x16x32_bf16 v[68:71], v[104:107], a[44:47], v[68:71]
    v_max_f32 v22, v22, v47
    v_mfma_f32_16x16x32_bf16 v[72:75], v[104:107], a[48:51], v[72:75]
    v_mfma_f32_16x16x32_bf16 v[76:79], v[104:107], a[52:55], v[76:79]
    v_max3_f32 v24, v48, v49, v50
    v_mfma_f32_16x16x32_bf16 v[80:83], v[104:107], a[56:59], v[80:83]
    v_mfma_f32_16x16x32_bf16 v[64:67], v[108:111], a[60:63], v[64:67]
    v_max_f32 v24, v24, v51
    v_mfma_f32_16x16x32_bf16 v[68:71], v[108:111], a[64:67], v[68:71]
    v_mfma_f32_16x16x32_bf16 v[72:75], v[108:111], a[68:71], v[72:75]
    v_max3_f32 v26, v52, v53, v54
    s_waitcnt vmcnt(12)
    v_mfma_f32_16x16x32_bf16 v[76:79], v[108:111], a[72:75], v[76:79]
    ds_read_b128 v[120:123], v14 offset:16384
    ds_read_b128 v[124:127], v15 offset:16384
    v_mfma_f32_16x16x32_bf16 v[80:83], v[108:111], a[76:79], v[80:83]
    v_max_f32 v26, v26, v55
    s_waitcnt lgkmcnt(2)
    v_mfma_f32_16x16x32_bf16 v[64:67], v[112:115], a[80:83], v[64:67]
    v_mfma_f32_16x16x32_bf16 v[68:71], v[112:115], a[84:87], v[68:71]
    v_max3_f32 v28, v56, v57, v58
    v_mfma_f32_16x16x32_bf16 v[72:75], v[112:115], a[88:91], v[72:75]
    v_mfma_f32_16x16x32_bf16 v[76:79], v[112:115], a[92:95], v[76:79]
    v_max_f32 v28, v28, v59
    s_add_u32 m0, s48, 12288
    s_mov_b32 s47, 24832
    buffer_load_dwordx4 v4, s[28:31], s47 offen nt lds
    buffer_load_dwordx4 v5, s[28:31], s47 offen offset:1024 nt lds
    v_mfma_f32_16x16x32_bf16 v[80:83], v[112:115], a[96:99], v[80:83]
    v_mfma_f32_16x16x32_bf16 v[64:67], v[116:119], a[100:103], v[64:67]
    v_max3_f32 v30, v60, v61, v62
    v_mfma_f32_16x16x32_bf16 v[68:71], v[116:119], a[104:107], v[68:71]
    v_mfma_f32_16x16x32_bf16 v[72:75], v[116:119], a[108:111], v[72:75]
    v_max_f32 v30, v30, v63
    v_mfma_f32_16x16x32_bf16 v[76:79], v[116:119], a[112:115], v[76:79]
    v_mfma_f32_16x16x32_bf16 v[80:83], v[116:119], a[116:119], v[80:83]
    s_waitcnt lgkmcnt(0)
    v_mfma_f32_16x16x32_bf16 v[64:67], v[120:123], a[120:123], v[64:67]
    v_mfma_f32_16x16x32_bf16 v[68:71], v[120:123], a[124:127], v[68:71]
    s_waitcnt vmcnt(12)
    ds_read_b128 v[128:131], v14
    v_mfma_f32_16x16x32_bf16 v[72:75], v[120:123], a[128:131], v[72:75]
    ds_read_b128 v[132:135], v15
    v_mfma_f32_16x16x32_bf16 v[76:79], v[120:123], a[132:135], v[76:79]
    v_mfma_f32_16x16x32_bf16 v[80:83], v[120:123], a[136:139], v[80:83]
    v_mfma_f32_16x16x32_bf16 v[64:67], v[124:127], a[140:143], v[64:67]
    v_mfma_f32_16x16x32_bf16 v[68:71], v[124:127], a[144:147], v[68:71]
    v_mfma_f32_16x16x32_bf16 v[72:75], v[124:127], a[148:151], v[72:75]
    s_add_u32 m0, s48, 14336
    s_mov_b32 s47, 24960
    buffer_load_dwordx4 v4, s[28:31], s47 offen nt lds
    buffer_load_dwordx4 v5, s[28:31], s47 offen offset:1024 nt lds
    v_mfma_f32_16x16x32_bf16 v[76:79], v[124:127], a[152:155], v[76:79]
    v_mfma_f32_16x16x32_bf16 v[80:83], v[124:127], a[156:159], v[80:83]
    s_waitcnt lgkmcnt(0)
    v_mfma_f32_16x16x32_bf16 v[96:99], v[128:131], a[0:3], 0
    v_mfma_f32_16x16x32_bf16 v[100:103], v[128:131], a[4:7], 0
    v_mfma_f32_16x16x32_bf16 v[104:107], v[128:131], a[8:11], 0
    s_waitcnt vmcnt(12)
    ds_read_b128 v[136:139], v14 offset:2048
    ds_read_b128 v[140:143], v15 offset:2048
    v_mfma_f32_16x16x32_bf16 v[108:111], v[128:131], a[12:15], 0
    v_mfma_f32_16x16x32_bf16 v[112:115], v[128:131], a[16:19], 0
    v_mfma_f32_16x16x32_bf16 v[96:99], v[132:135], a[20:23], v[96:99]
    v_mfma_f32_16x16x32_bf16 v[100:103], v[132:135], a[24:27], v[100:103]
    v_mfma_f32_16x16x32_bf16 v[104:107], v[132:135], a[28:31], v[104:107]
    v_mfma_f32_16x16x32_bf16 v[108:111], v[132:135], a[32:35], v[108:111]
    v_mfma_f32_16x16x32_bf16 v[112:115], v[132:135], a[36:39], v[112:115]
    v_max3_f32 v22, v22, v64, v65
    s_waitcnt lgkmcnt(0)
    v_mfma_f32_16x16x32_bf16 v[96:99], v[136:139], a[40:43], v[96:99]
    v_mfma_f32_16x16x32_bf16 v[100:103], v[136:139], a[44:47], v[100:103]
    v_max3_f32 v22, v22, v66, v67
    s_add_u32 m0, s48, 16384
    s_mov_b32 s47, 32768
    buffer_load_dwordx4 v4, s[28:31], s47 offen nt lds
    buffer_load_dwordx4 v5, s[28:31], s47 offen offset:1024 nt lds
    v_mfma_f32_16x16x32_bf16 v[104:107], v[136:139], a[48:51], v[104:107]
    s_waitcnt vmcnt(12)
    ds_read_b128 v[144:147], v14 offset:4096
    ds_read_b128 v[148:151], v15 offset:4096
    v_mfma_f32_16x16x32_bf16 v[108:111], v[136:139], a[52:55], v[108:111]
    v_max3_f32 v24, v24, v68, v69
    v_mfma_f32_16x16x32_bf16 v[112:115], v[136:139], a[56:59], v[112:115]
    v_mfma_f32_16x16x32_bf16 v[96:99], v[140:143], a[60:63], v[96:99]
    v_max3_f32 v24, v24, v70, v71
    v_mfma_f32_16x16x32_bf16 v[100:103], v[140:143], a[64:67], v[100:103]
    v_mfma_f32_16x16x32_bf16 v[104:107], v[140:143], a[68:71], v[104:107]
    v_max3_f32 v26, v26, v72, v73
    v_mfma_f32_16x16x32_bf16 v[108:111], v[140:143], a[72:75], v[108:111]
    v_mfma_f32_16x16x32_bf16 v[112:115], v[140:143], a[76:79], v[112:115]
    v_max3_f32 v26, v26, v74, v75
    s_waitcnt lgkmcnt(0)
    v_mfma_f32_16x16x32_bf16 v[96:99], v[144:147], a[80:83], v[96:99]
    v_mfma_f32_16x16x32_bf16 v[100:103], v[144:147], a[84:87], v[100:103]
    v_max3_f32 v28, v28, v76, v77
    v_mfma_f32_16x16x32_bf16 v[104:107], v[144:147], a[88:91], v[104:107]
    s_waitcnt vmcnt(10)
    ds_read_b128 v[152:155], v14 offset:6144
    ds_read_b128 v[156:159], v15 offset:6144
    v_mfma_f32_16x16x32_bf16 v[108:111], v[144:147], a[92:95], v[108:111]
    v_max3_f32 v28, v28, v78, v79
    v_mfma_f32_16x16x32_bf16 v[112:115], v[144:147], a[96:99], v[112:115]
    s_add_u32 m0, s48, 0
    s_mov_b32 s47, 32896
    buffer_load_dwordx4 v4, s[28:31], s47 offen nt lds
    buffer_load_dwordx4 v5, s[28:31], s47 offen offset:1024 nt lds
    v_mfma_f32_16x16x32_bf16 v[96:99], v[148:151], a[100:103], v[96:99]
    v_max3_f32 v30, v30, v80, v81
    v_mfma_f32_16x16x32_bf16 v[100:103], v[148:151], a[104:107], v[100:103]
    v_mfma_f32_16x16x32_bf16 v[104:107], v[148:151], a[108:111], v[104:107]
    v_max3_f32 v30, v30, v82, v83
    v_mfma_f32_16x16x32_bf16 v[108:111], v[148:151], a[112:115], v[108:111]
    v_mfma_f32_16x16x32_bf16 v[112:115], v[148:151], a[116:119], v[112:115]
    s_waitcnt lgkmcnt(0)
    v_mfma_f32_16x16x32_bf16 v[96:99], v[152:155], a[120:123], v[96:99]
    v_mfma_f32_16x16x32_bf16 v[100:103], v[152:155], a[124:127], v[100:103]
    v_mfma_f32_16x16x32_bf16 v[104:107], v[152:155], a[128:131], v[104:107]
    s_waitcnt vmcnt(10)
    ds_read_b128 v[160:163], v14 offset:8192
    ds_read_b128 v[164:167], v15 offset:8192
    v_mfma_f32_16x16x32_bf16 v[108:111], v[152:155], a[132:135], v[108:111]
    v_mfma_f32_16x16x32_bf16 v[112:115], v[152:155], a[136:139], v[112:115]
    v_mfma_f32_16x16x32_bf16 v[96:99], v[156:159], a[140:143], v[96:99]
    v_mfma_f32_16x16x32_bf16 v[100:103], v[156:159], a[144:147], v[100:103]
    v_mfma_f32_16x16x32_bf16 v[104:107], v[156:159], a[148:151], v[104:107]
    v_mfma_f32_16x16x32_bf16 v[108:111], v[156:159], a[152:155], v[108:111]
    s_add_u32 m0, s48, 2048
    s_mov_b32 s47, 33024
    buffer_load_dwordx4 v4, s[28:31], s47 offen nt lds
    buffer_load_dwordx4 v5, s[28:31], s47 offen offset:1024 nt lds
    v_mfma_f32_16x16x32_bf16 v[112:115], v[156:159], a[156:159], v[112:115]
    s_waitcnt lgkmcnt(0)
    v_mfma_f32_16x16x32_bf16 v[128:131], v[160:163], a[0:3], 0
    v_mfma_f32_16x16x32_bf16 v[132:135], v[160:163], a[4:7], 0
    v_mfma_f32_16x16x32_bf16 v[136:139], v[160:163], a[8:11], 0
    s_waitcnt vmcnt(10)
    ds_read_b128 v[168:171], v14 offset:10240
    ds_read_b128 v[172:175], v15 offset:10240
    v_mfma_f32_16x16x32_bf16 v[140:143], v[160:163], a[12:15], 0
    v_mfma_f32_16x16x32_bf16 v[144:147], v[160:163], a[16:19], 0
    v_mfma_f32_16x16x32_bf16 v[128:131], v[164:167], a[20:23], v[128:131]
    v_mfma_f32_16x16x32_bf16 v[132:135], v[164:167], a[24:27], v[132:135]
    v_mfma_f32_16x16x32_bf16 v[136:139], v[164:167], a[28:31], v[136:139]
    v_mfma_f32_16x16x32_bf16 v[140:143], v[164:167], a[32:35], v[140:143]
    v_mfma_f32_16x16x32_bf16 v[144:147], v[164:167], a[36:39], v[144:147]
    v_max3_f32 v22, v22, v96, v97
    s_waitcnt lgkmcnt(0)
    v_mfma_f32_16x16x32_bf16 v[128:131], v[168:171], a[40:43], v[128:131]
    v_mfma_f32_16x16x32_bf16 v[132:135], v[168:171], a[44:47], v[132:135]
    v_max3_f32 v22, v22, v98, v99
    v_mfma_f32_16x16x32_bf16 v[136:139], v[168:171], a[48:51], v[136:139]
    s_add_u32 m0, s48, 4096
    s_mov_b32 s47, 33152
    buffer_load_dwordx4 v4, s[28:31], s47 offen nt lds
    buffer_load_dwordx4 v5, s[28:31], s47 offen offset:1024 nt lds
    s_waitcnt vmcnt(10)
    ds_read_b128 v[176:179], v14 offset:12288
    ds_read_b128 v[180:183], v15 offset:12288
    v_mfma_f32_16x16x32_bf16 v[140:143], v[168:171], a[52:55], v[140:143]
    v_max3_f32 v24, v24, v100, v101
    v_mfma_f32_16x16x32_bf16 v[144:147], v[168:171], a[56:59], v[144:147]
    v_mfma_f32_16x16x32_bf16 v[128:131], v[172:175], a[60:63], v[128:131]
    v_max3_f32 v24, v24, v102, v103
    v_mfma_f32_16x16x32_bf16 v[132:135], v[172:175], a[64:67], v[132:135]
    v_mfma_f32_16x16x32_bf16 v[136:139], v[172:175], a[68:71], v[136:139]
    v_max3_f32 v26, v26, v104, v105
    v_mfma_f32_16x16x32_bf16 v[140:143], v[172:175], a[72:75], v[140:143]
    v_mfma_f32_16x16x32_bf16 v[144:147], v[172:175], a[76:79], v[144:147]
    v_max3_f32 v26, v26, v106, v107
    s_waitcnt lgkmcnt(0)
    v_mfma_f32_16x16x32_bf16 v[128:131], v[176:179], a[80:83], v[128:131]
    v_mfma_f32_16x16x32_bf16 v[132:135], v[176:179], a[84:87], v[132:135]
    v_max3_f32 v28, v28, v108, v109
    v_mfma_f32_16x16x32_bf16 v[136:139], v[176:179], a[88:91], v[136:139]
    s_waitcnt vmcnt(8)
    ds_read_b128 v[184:187], v14 offset:14336
    ds_read_b128 v[188:191], v15 offset:14336
    s_add_u32 m0, s48, 6144
    s_mov_b32 s47, 40960
    buffer_load_dwordx4 v4, s[28:31], s47 offen nt lds
    buffer_load_dwordx4 v5, s[28:31], s47 offen offset:1024 nt lds
    v_mfma_f32_16x16x32_bf16 v[140:143], v[176:179], a[92:95], v[140:143]
    v_max3_f32 v28, v28, v110, v111
    v_mfma_f32_16x16x32_bf16 v[144:147], v[176:179], a[96:99], v[144:147]
    v_mfma_f32_16x16x32_bf16 v[128:131], v[180:183], a[100:103], v[128:131]
    v_max3_f32 v30, v30, v112, v113
    v_mfma_f32_16x16x32_bf16 v[132:135], v[180:183], a[104:107], v[132:135]
    v_mfma_f32_16x16x32_bf16 v[136:139], v[180:183], a[108:111], v[136:139]
    v_max3_f32 v30, v30, v114, v115
    v_mfma_f32_16x16x32_bf16 v[140:143], v[180:183], a[112:115], v[140:143]
    v_mfma_f32_16x16x32_bf16 v[144:147], v[180:183], a[116:119], v[144:147]
    s_waitcnt lgkmcnt(0)
    v_mfma_f32_16x16x32_bf16 v[128:131], v[184:187], a[120:123], v[128:131]
    v_mfma_f32_16x16x32_bf16 v[132:135], v[184:187], a[124:127], v[132:135]
    v_mfma_f32_16x16x32_bf16 v[136:139], v[184:187], a[128:131], v[136:139]
    s_waitcnt vmcnt(8)
    ds_read_b128 v[192:195], v14 offset:16384
    ds_read_b128 v[196:199], v15 offset:16384
    s_add_u32 m0, s48, 8192
    s_mov_b32 s47, 41088
    buffer_load_dwordx4 v4, s[28:31], s47 offen nt lds
    buffer_load_dwordx4 v5, s[28:31], s47 offen offset:1024 nt lds
    v_mfma_f32_16x16x32_bf16 v[140:143], v[184:187], a[132:135], v[140:143]
    v_mfma_f32_16x16x32_bf16 v[144:147], v[184:187], a[136:139], v[144:147]
    v_mfma_f32_16x16x32_bf16 v[128:131], v[188:191], a[140:143], v[128:131]
    v_mfma_f32_16x16x32_bf16 v[132:135], v[188:191], a[144:147], v[132:135]
    v_mfma_f32_16x16x32_bf16 v[136:139], v[188:191], a[148:151], v[136:139]
    v_mfma_f32_16x16x32_bf16 v[140:143], v[188:191], a[152:155], v[140:143]
    v_mfma_f32_16x16x32_bf16 v[144:147], v[188:191], a[156:159], v[144:147]
    s_waitcnt lgkmcnt(0)
    v_mfma_f32_16x16x32_bf16 v[160:163], v[192:195], a[0:3], 0
    v_mfma_f32_16x16x32_bf16 v[164:167], v[192:195], a[4:7], 0
    v_mfma_f32_16x16x32_bf16 v[168:171], v[192:195], a[8:11], 0
    s_waitcnt vmcnt(8)
    ds_read_b128 v[200:203], v14
    ds_read_b128 v[204:207], v15
    s_add_u32 m0, s48, 10240
    s_mov_b32 s47, 41216
    buffer_load_dwordx4 v4, s[28:31], s47 offen nt lds
    buffer_load_dwordx4 v5, s[28:31], s47 offen offset:1024 nt lds
    v_mfma_f32_16x16x32_bf16 v[172:175], v[192:195], a[12:15], 0
    v_max3_f32 v22, v22, v128, v129
    v_max3_f32 v22, v22, v130, v131
    v_mfma_f32_16x16x32_bf16 v[176:179], v[192:195], a[16:19], 0
    v_max3_f32 v24, v24, v132, v133
    v_max3_f32 v24, v24, v134, v135
    v_mfma_f32_16x16x32_bf16 v[160:163], v[196:199], a[20:23], v[160:163]
    v_max3_f32 v26, v26, v136, v137
    v_max3_f32 v26, v26, v138, v139
    v_mfma_f32_16x16x32_bf16 v[164:167], v[196:199], a[24:27], v[164:167]
    v_max3_f32 v28, v28, v140, v141
    v_max3_f32 v28, v28, v142, v143
    v_mfma_f32_16x16x32_bf16 v[168:171], v[196:199], a[28:31], v[168:171]
    v_max3_f32 v30, v30, v144, v145
    v_max3_f32 v30, v30, v146, v147
    v_mov_b32 v23, v22
    v_mfma_f32_16x16x32_bf16 v[172:175], v[196:199], a[32:35], v[172:175]
    v_mov_b32 v25, v24
    v_mov_b32 v27, v26
    v_mfma_f32_16x16x32_bf16 v[176:179], v[196:199], a[36:39], v[176:179]
    v_mov_b32 v29, v28
    v_mov_b32 v31, v30
    s_waitcnt lgkmcnt(0)
    v_mfma_f32_16x16x32_bf16 v[160:163], v[200:203], a[40:43], v[160:163]
    v_permlane16_swap_b32 v22, v23
    v_permlane16_swap_b32 v24, v25
    v_mfma_f32_16x16x32_bf16 v[164:167], v[200:203], a[44:47], v[164:167]
    v_permlane16_swap_b32 v26, v27
    v_permlane16_swap_b32 v28, v29
    v_mfma_f32_16x16x32_bf16 v[168:171], v[200:203], a[48:51], v[168:171]
    v_permlane16_swap_b32 v30, v31
    v_max_f32 v22, v22, v23
    s_waitcnt vmcnt(8)
    ds_read_b128 v[208:211], v14 offset:2048
    ds_read_b128 v[212:215], v15 offset:2048
    s_add_u32 m0, s48, 12288
    s_mov_b32 s47, 41344
    buffer_load_dwordx4 v4, s[28:31], s47 offen nt lds
    buffer_load_dwordx4 v5, s[28:31], s47 offen offset:1024 nt lds
    v_mfma_f32_16x16x32_bf16 v[172:175], v[200:203], a[52:55], v[172:175]
    v_max_f32 v24, v24, v25
    v_max_f32 v26, v26, v27
    v_mfma_f32_16x16x32_bf16 v[176:179], v[200:203], a[56:59], v[176:179]
    v_max_f32 v28, v28, v29
    v_max_f32 v30, v30, v31
    v_mfma_f32_16x16x32_bf16 v[160:163], v[204:207], a[60:63], v[160:163]
    v_mov_b32 v23, v22
    v_mov_b32 v25, v24
    v_mov_b32 v27, v26
    v_mfma_f32_16x16x32_bf16 v[164:167], v[204:207], a[64:67], v[164:167]
    v_mov_b32 v29, v28
    v_mov_b32 v31, v30
    v_mfma_f32_16x16x32_bf16 v[168:171], v[204:207], a[68:71], v[168:171]
    v_permlane32_swap_b32 v22, v23
    v_permlane32_swap_b32 v24, v25
    v_mfma_f32_16x16x32_bf16 v[172:175], v[204:207], a[72:75], v[172:175]
    v_permlane32_swap_b32 v26, v27
    v_permlane32_swap_b32 v28, v29
    v_mfma_f32_16x16x32_bf16 v[176:179], v[204:207], a[76:79], v[176:179]
    v_permlane32_swap_b32 v30, v31
    v_max_f32 v22, v22, v23
    s_waitcnt lgkmcnt(0)
    v_mfma_f32_16x16x32_bf16 v[160:163], v[208:211], a[80:83], v[160:163]
    v_max_f32 v24, v24, v25
    v_max_f32 v26, v26, v27
    v_mfma_f32_16x16x32_bf16 v[164:167], v[208:211], a[84:87], v[164:167]
    v_max_f32 v28, v28, v29
    v_max_f32 v30, v30, v31
    v_mfma_f32_16x16x32_bf16 v[168:171], v[208:211], a[88:91], v[168:171]
    ds_write_b32 v19, v22
    ds_write_b32 v19, v24 offset:256
    s_waitcnt vmcnt(8)
    ds_read_b128 v[216:219], v14 offset:4096
    ds_read_b128 v[220:223], v15 offset:4096
    s_add_u32 m0, s48, 14336
    s_mov_b32 s47, 49152
    buffer_load_dwordx4 v4, s[28:31], s47 offen nt lds
    buffer_load_dwordx4 v5, s[28:31], s47 offen offset:1024 nt lds
    v_mfma_f32_16x16x32_bf16 v[172:175], v[208:211], a[92:95], v[172:175]
    ds_write_b32 v19, v26 offset:512
    ds_write_b32 v19, v28 offset:768
    ds_write_b32 v19, v30 offset:1024
    v_mfma_f32_16x16x32_bf16 v[176:179], v[208:211], a[96:99], v[176:179]
    v_mfma_f32_16x16x32_bf16 v[160:163], v[212:215], a[100:103], v[160:163]
    v_mfma_f32_16x16x32_bf16 v[164:167], v[212:215], a[104:107], v[164:167]
    v_mfma_f32_16x16x32_bf16 v[168:171], v[212:215], a[108:111], v[168:171]
    s_waitcnt lgkmcnt(0)
    s_barrier
    ds_read_b128 v[84:87], v20
    v_mfma_f32_16x16x32_bf16 v[172:175], v[212:215], a[112:115], v[172:175]
    ds_read_b128 v[88:91], v20 offset:256
    ds_read_b128 v[92:95], v20 offset:512
    v_mfma_f32_16x16x32_bf16 v[176:179], v[212:215], a[116:119], v[176:179]
    ds_read_b128 v[116:119], v20 offset:768
    ds_read_b128 v[120:123], v20 offset:1024
    v_mfma_f32_16x16x32_bf16 v[160:163], v[216:219], a[120:123], v[160:163]
    v_mfma_f32_16x16x32_bf16 v[164:167], v[216:219], a[124:127], v[164:167]
    v_mfma_f32_16x16x32_bf16 v[168:171], v[216:219], a[128:131], v[168:171]
    s_waitcnt lgkmcnt(0)
    s_waitcnt vmcnt(8)
    ds_read_b128 v[224:227], v14 offset:6144
    ds_read_b128 v[228:231], v15 offset:6144
    s_add_u32 m0, s48, 16384
    s_mov_b32 s47, 49280
    buffer_load_dwordx4 v4, s[28:31], s47 offen nt lds
    buffer_load_dwordx4 v5, s[28:31], s47 offen offset:1024 nt lds
    v_mfma_f32_16x16x32_bf16 v[172:175], v[216:219], a[132:135], v[172:175]
    v_max3_f32 v22, v84, v85, v86
    v_max_f32 v22, v22, v87
    v_mfma_f32_16x16x32_bf16 v[176:179], v[216:219], a[136:139], v[176:179]
    v_max3_f32 v24, v88, v89, v90
    v_max_f32 v24, v24, v91
    v_mfma_f32_16x16x32_bf16 v[160:163], v[220:223], a[140:143], v[160:163]
    v_max3_f32 v26, v92, v93, v94
    v_max_f32 v26, v26, v95
    v_mfma_f32_16x16x32_bf16 v[164:167], v[220:223], a[144:147], v[164:167]
    v_max3_f32 v28, v116, v117, v118
    v_max_f32 v28, v28, v119
    v_mfma_f32_16x16x32_bf16 v[168:171], v[220:223], a[148:151], v[168:171]
    v_max3_f32 v30, v120, v121, v122
    v_max_f32 v30, v30, v123
    v_mfma_f32_16x16x32_bf16 v[172:175], v[220:223], a[152:155], v[172:175]
    v_mul_f32 v22, s50, v22
    v_mul_f32 v24, s50, v24
    v_mfma_f32_16x16x32_bf16 v[176:179], v[220:223], a[156:159], v[176:179]
    v_mul_f32 v26, s50, v26
    v_mul_f32 v28, s50, v28
    v_mul_f32 v30, s50, v30
    s_waitcnt lgkmcnt(0)
    v_mfma_f32_16x16x32_bf16 v[192:195], v[224:227], a[0:3], 0
    v_fma_f32 v44, v44, s50, -v22
    v_fma_f32 v45, v45, s50, -v22
    v_mfma_f32_16x16x32_bf16 v[196:199], v[224:227], a[4:7], 0
    v_fma_f32 v46, v46, s50, -v22
    v_fma_f32 v47, v47, s50, -v22
    v_exp_f32 v44, v44
    v_mfma_f32_16x16x32_bf16 v[200:203], v[224:227], a[8:11], 0
    v_exp_f32 v45, v45
    v_exp_f32 v46, v46
    s_waitcnt vmcnt(8)
    ds_read_b128 v[232:235], v14 offset:8192
    ds_read_b128 v[236:239], v15 offset:8192
    s_add_u32 m0, s48, 0
    s_mov_b32 s47, 49408
    buffer_load_dwordx4 v4, s[28:31], s47 offen nt lds
    buffer_load_dwordx4 v5, s[28:31], s47 offen offset:1024 nt lds
    v_mfma_f32_16x16x32_bf16 v[204:207], v[224:227], a[12:15], 0
    v_exp_f32 v47, v47
    v_fma_f32 v64, v64, s50, -v22
    v_fma_f32 v65, v65, s50, -v22
    v_mfma_f32_16x16x32_bf16 v[208:211], v[224:227], a[16:19], 0
    v_fma_f32 v66, v66, s50, -v22
    v_fma_f32 v67, v67, s50, -v22
    v_max3_f32 v33, v160, v161, v162
    v_mfma_f32_16x16x32_bf16 v[192:195], v[228:231], a[20:23], v[192:195]
    v_max_f32 v33, v33, v163
    v_max3_f32 v35, v164, v165, v166
    v_mfma_f32_16x16x32_bf16 v[196:199], v[228:231], a[24:27], v[196:199]
    v_max_f32 v35, v35, v167
    v_max3_f32 v37, v168, v169, v170
    v_max_f32 v37, v37, v171
    v_mfma_f32_16x16x32_bf16 v[200:203], v[228:231], a[28:31], v[200:203]
    v_max3_f32 v39, v172, v173, v174
    v_max_f32 v39, v39, v175
    v_max3_f32 v41, v176, v177, v178
    v_mfma_f32_16x16x32_bf16 v[204:207], v[228:231], a[32:35], v[204:207]
    v_max_f32 v41, v41, v179
    v_exp_f32 v64, v64
    v_mfma_f32_16x16x32_bf16 v[208:211], v[228:231], a[36:39], v[208:211]
    v_exp_f32 v65, v65
    v_exp_f32 v66, v66
    v_exp_f32 v67, v67
    s_waitcnt lgkmcnt(0)
    v_mfma_f32_16x16x32_bf16 v[192:195], v[232:235], a[40:43], v[192:195]
    v_cvt_pk_bf16_f32 v148, v44, v45
    v_cvt_pk_bf16_f32 v149, v46, v47
    v_mfma_f32_16x16x32_bf16 v[196:199], v[232:235], a[44:47], v[196:199]
    v_add_f32 v32, v44, v45
    v_add_f32 v32, v32, v46
    v_add_f32 v32, v32, v47
    v_mfma_f32_16x16x32_bf16 v[200:203], v[232:235], a[48:51], v[200:203]
    v_cvt_pk_bf16_f32 v150, v64, v65
    v_cvt_pk_bf16_f32 v151, v66, v67
    v_add_f32 v32, v32, v64
    s_add_u32 m0, s48, 2048
    s_mov_b32 s47, 49536
    buffer_load_dwordx4 v4, s[28:31], s47 offen nt lds
    buffer_load_dwordx4 v5, s[28:31], s47 offen offset:1024 nt lds
    s_waitcnt vmcnt(10)
    ds_read_b128 v[240:243], v14 offset:10240
    ds_read_b128 v[244:247], v15 offset:10240
    v_mfma_f32_16x16x32_bf16 v[204:207], v[232:235], a[52:55], v[204:207]
    v_add_f32 v32, v32, v65
    v_add_f32 v32, v32, v66
    v_mfma_f32_16x16x32_bf16 v[208:211], v[232:235], a[56:59], v[208:211]
    v_add_f32 v32, v32, v67
    ds_write_b128 v21, v[148:151]
    v_fma_f32 v48, v48, s50, -v24
    v_mfma_f32_16x16x32_bf16 v[192:195], v[236:239], a[60:63], v[192:195]
    v_fma_f32 v49, v49, s50, -v24
    v_fma_f32 v50, v50, s50, -v24
    v_fma_f32 v51, v51, s50, -v24
    v_mfma_f32_16x16x32_bf16 v[196:199], v[236:239], a[64:67], v[196:199]
    v_exp_f32 v48, v48
    v_exp_f32 v49, v49
    v_mfma_f32_16x16x32_bf16 v[200:203], v[236:239], a[68:71], v[200:203]
    v_exp_f32 v50, v50
    v_exp_f32 v51, v51
    v_fma_f32 v68, v68, s50, -v24
    v_mfma_f32_16x16x32_bf16 v[204:207], v[236:239], a[72:75], v[204:207]
    v_fma_f32 v69, v69, s50, -v24
    v_fma_f32 v70, v70, s50, -v24
    v_mfma_f32_16x16x32_bf16 v[208:211], v[236:239], a[76:79], v[208:211]
    v_fma_f32 v71, v71, s50, -v24
    v_exp_f32 v68, v68
    v_exp_f32 v69, v69
    s_waitcnt lgkmcnt(1)
    v_mfma_f32_16x16x32_bf16 v[192:195], v[240:243], a[80:83], v[192:195]
    v_exp_f32 v70, v70
    v_exp_f32 v71, v71
    v_cvt_pk_bf16_f32 v152, v48, v49
    v_mfma_f32_16x16x32_bf16 v[196:199], v[240:243], a[84:87], v[196:199]
    v_cvt_pk_bf16_f32 v153, v50, v51
    v_add_f32 v34, v48, v49
    v_mfma_f32_16x16x32_bf16 v[200:203], v[240:243], a[88:91], v[200:203]
    v_add_f32 v34, v34, v50
    v_add_f32 v34, v34, v51
    v_cvt_pk_bf16_f32 v154, v68, v69
    s_add_u32 m0, s48, 4096
    s_mov_b32 s47, 57344
    buffer_load_dwordx4 v4, s[28:31], s47 offen nt lds
    buffer_load_dwordx4 v5, s[28:31], s47 offen offset:1024 nt lds
    s_waitcnt vmcnt(10)
    ds_read_b128 v[248:251], v14 offset:12288
    ds_read_b128 v[252:255], v15 offset:12288
    v_mfma_f32_16x16x32_bf16 v[204:207], v[240:243], a[92:95], v[204:207]
    v_cvt_pk_bf16_f32 v155, v70, v71
    v_add_f32 v34, v34, v68
    v_add_f32 v34, v34, v69
    v_mfma_f32_16x16x32_bf16 v[208:211], v[240:243], a[96:99], v[208:211]
    v_add_f32 v34, v34, v70
    v_add_f32 v34, v34, v71
    v_mfma_f32_16x16x32_bf16 v[192:195], v[244:247], a[100:103], v[192:195]
    ds_write_b128 v21, v[152:155] offset:1024
    v_fma_f32 v52, v52, s50, -v26
    v_fma_f32 v53, v53, s50, -v26
    v_mfma_f32_16x16x32_bf16 v[196:199], v[244:247], a[104:107], v[196:199]
    v_fma_f32 v54, v54, s50, -v26
    v_fma_f32 v55, v55, s50, -v26
    v_mfma_f32_16x16x32_bf16 v[200:203], v[244:247], a[108:111], v[200:203]
    v_exp_f32 v52, v52
    v_exp_f32 v53, v53
    v_exp_f32 v54, v54
    v_mfma_f32_16x16x32_bf16 v[204:207], v[244:247], a[112:115], v[204:207]
    v_exp_f32 v55, v55
    v_fma_f32 v72, v72, s50, -v26
    v_fma_f32 v73, v73, s50, -v26
    v_mfma_f32_16x16x32_bf16 v[208:211], v[244:247], a[116:119], v[208:211]
    v_fma_f32 v74, v74, s50, -v26
    v_fma_f32 v75, v75, s50, -v26
    s_waitcnt lgkmcnt(1)
    v_mfma_f32_16x16x32_bf16 v[192:195], v[248:251], a[120:123], v[192:195]
    v_exp_f32 v72, v72
    v_exp_f32 v73, v73
    v_exp_f32 v74, v74
    v_mfma_f32_16x16x32_bf16 v[196:199], v[248:251], a[124:127], v[196:199]
    v_exp_f32 v75, v75
    v_cvt_pk_bf16_f32 v156, v52, v53
    v_cvt_pk_bf16_f32 v157, v54, v55
    s_add_u32 m0, s48, 6144
    s_mov_b32 s47, 57472
    buffer_load_dwordx4 v4, s[28:31], s47 offen nt lds
    buffer_load_dwordx4 v5, s[28:31], s47 offen offset:1024 nt lds
    v_mfma_f32_16x16x32_bf16 v[200:203], v[248:251], a[128:131], v[200:203]
    v_add_f32 v36, v52, v53
    v_add_f32 v36, v36, v54
    s_waitcnt vmcnt(10)
    ds_read_b128 a[160:163], v14 offset:14336
    ds_read_b128 a[164:167], v15 offset:14336
    v_mfma_f32_16x16x32_bf16 v[204:207], v[248:251], a[132:135], v[204:207]
    v_add_f32 v36, v36, v55
    v_cvt_pk_bf16_f32 v158, v72, v73
    v_cvt_pk_bf16_f32 v159, v74, v75
    v_mfma_f32_16x16x32_bf16 v[208:211], v[248:251], a[136:139], v[208:211]
    v_add_f32 v36, v36, v72
    v_add_f32 v36, v36, v73
    v_mfma_f32_16x16x32_bf16 v[192:195], v[252:255], a[140:143], v[192:195]
    v_add_f32 v36, v36, v74
    v_add_f32 v36, v36, v75
    ds_write_b128 v21, v[156:159] offset:2048
    v_mfma_f32_16x16x32_bf16 v[196:199], v[252:255], a[144:147], v[196:199]
    v_fma_f32 v56, v56, s50, -v28
    v_fma_f32 v57, v57, s50, -v28
    v_fma_f32 v58, v58, s50, -v28
    v_mfma_f32_16x16x32_bf16 v[200:203], v[252:255], a[148:151], v[200:203]
    v_fma_f32 v59, v59, s50, -v28
    v_exp_f32 v56, v56
    v_mfma_f32_16x16x32_bf16 v[204:207], v[252:255], a[152:155], v[204:207]
    v_exp_f32 v57, v57
    v_exp_f32 v58, v58
    v_exp_f32 v59, v59
    v_mfma_f32_16x16x32_bf16 v[208:211], v[252:255], a[156:159], v[208:211]
    v_fma_f32 v76, v76, s50, -v28
    v_fma_f32 v77, v77, s50, -v28
    v_fma_f32 v78, v78, s50, -v28
    s_waitcnt lgkmcnt(1)
    v_mfma_f32_16x16x32_bf16 v[224:227], a[160:163], a[0:3], 0
    v_fma_f32 v79, v79, s50, -v28
    v_exp_f32 v76, v76
    v_mfma_f32_16x16x32_bf16 v[228:231], a[160:163], a[4:7], 0
    v_exp_f32 v77, v77
    v_exp_f32 v78, v78
    v_exp_f32 v79, v79
    s_add_u32 m0, s48, 8192
    s_mov_b32 s47, 57600
    buffer_load_dwordx4 v4, s[28:31], s47 offen nt lds
    buffer_load_dwordx4 v5, s[28:31], s47 offen offset:1024 nt lds
    v_mfma_f32_16x16x32_bf16 v[232:235], a[160:163], a[8:11], 0
    v_cvt_pk_bf16_f32 v180, v56, v57
    v_cvt_pk_bf16_f32 v181, v58, v59
    s_waitcnt vmcnt(10)
    ds_read_b128 a[168:171], v14 offset:16384
    ds_read_b128 a[172:175], v15 offset:16384
    v_mfma_f32_16x16x32_bf16 v[236:239], a[160:163], a[12:15], 0
    v_add_f32 v38, v56, v57
    v_add_f32 v38, v38, v58
    v_add_f32 v38, v38, v59
    v_mfma_f32_16x16x32_bf16 v[240:243], a[160:163], a[16:19], 0
    v_cvt_pk_bf16_f32 v182, v76, v77
    v_cvt_pk_bf16_f32 v183, v78, v79
    v_max3_f32 v33, v33, v192, v193
    v_mfma_f32_16x16x32_bf16 v[224:227], a[164:167], a[20:23], v[224:227]
    v_max3_f32 v33, v33, v194, v195
    v_max3_f32 v35, v35, v196, v197
    v_mfma_f32_16x16x32_bf16 v[228:231], a[164:167], a[24:27], v[228:231]
    v_max3_f32 v35, v35, v198, v199
    v_max3_f32 v37, v37, v200, v201
    v_max3_f32 v37, v37, v202, v203
    v_mfma_f32_16x16x32_bf16 v[232:235], a[164:167], a[28:31], v[232:235]
    v_max3_f32 v39, v39, v204, v205
    v_max3_f32 v39, v39, v206, v207
    v_max3_f32 v41, v41, v208, v209
    v_mfma_f32_16x16x32_bf16 v[236:239], a[164:167], a[32:35], v[236:239]
    v_max3_f32 v41, v41, v210, v211
    v_add_f32 v38, v38, v76
    v_mfma_f32_16x16x32_bf16 v[240:243], a[164:167], a[36:39], v[240:243]
    v_add_f32 v38, v38, v77
    v_add_f32 v38, v38, v78
    v_add_f32 v38, v38, v79
    s_waitcnt lgkmcnt(0)
    v_mfma_f32_16x16x32_bf16 v[224:227], a[168:171], a[40:43], v[224:227]
    ds_write_b128 v21, v[180:183] offset:3072
    v_fma_f32 v60, v60, s50, -v30
    v_mfma_f32_16x16x32_bf16 v[228:231], a[168:171], a[44:47], v[228:231]
    v_fma_f32 v61, v61, s50, -v30
    v_fma_f32 v62, v62, s50, -v30
    v_fma_f32 v63, v63, s50, -v30
    s_add_u32 m0, s48, 10240
    s_mov_b32 s47, 57728
    buffer_load_dwordx4 v4, s[28:31], s47 offen nt lds
    buffer_load_dwordx4 v5, s[28:31], s47 offen offset:1024 nt lds
    v_mfma_f32_16x16x32_bf16 v[232:235], a[168:171], a[48:51], v[232:235]
    v_exp_f32 v60, v60
    v_exp_f32 v61, v61
    v_exp_f32 v62, v62
    s_waitcnt vmcnt(10)
    ds_read_b128 a[176:179], v14
    ds_read_b128 a[180:183], v15
    v_mfma_f32_16x16x32_bf16 v[236:239], a[168:171], a[52:55], v[236:239]
    v_exp_f32 v63, v63
    v_fma_f32 v80, v80, s50, -v30
    v_mfma_f32_16x16x32_bf16 v[240:243], a[168:171], a[56:59], v[240:243]
    v_fma_f32 v81, v81, s50, -v30
    v_fma_f32 v82, v82, s50, -v30
    v_fma_f32 v83, v83, s50, -v30
    v_mfma_f32_16x16x32_bf16 v[224:227], a[172:175], a[60:63], v[224:227]
    v_exp_f32 v80, v80
    v_exp_f32 v81, v81
    v_exp_f32 v82, v82
    v_mfma_f32_16x16x32_bf16 v[228:231], a[172:175], a[64:67], v[228:231]
    v_exp_f32 v83, v83
    v_cvt_pk_bf16_f32 v148, v60, v61
    v_mfma_f32_16x16x32_bf16 v[232:235], a[172:175], a[68:71], v[232:235]
    v_cvt_pk_bf16_f32 v149, v62, v63
    v_add_f32 v40, v60, v61
    v_add_f32 v40, v40, v62
    v_mfma_f32_16x16x32_bf16 v[236:239], a[172:175], a[72:75], v[236:239]
    v_add_f32 v40, v40, v63
    v_cvt_pk_bf16_f32 v150, v80, v81
    v_mfma_f32_16x16x32_bf16 v[240:243], a[172:175], a[76:79], v[240:243]
    v_cvt_pk_bf16_f32 v151, v82, v83
    v_add_f32 v40, v40, v80
    v_add_f32 v40, v40, v81
    s_waitcnt lgkmcnt(0)
    v_mfma_f32_16x16x32_bf16 v[224:227], a[176:179], a[80:83], v[224:227]
    v_add_f32 v40, v40, v82
    v_add_f32 v40, v40, v83
    ds_write_b128 v21, v[148:151] offset:4096
    s_add_u32 m0, s48, 12288
    s_mov_b32 s47, 0
    buffer_load_dwordx4 v8, s[32:35], s47 offen nt lds
    buffer_load_dwordx4 v9, s[32:35], s47 offen offset:1024 nt lds
    v_mfma_f32_16x16x32_bf16 v[228:231], a[176:179], a[84:87], v[228:231]
    v_fma_f32 v96, v96, s50, -v22
    v_fma_f32 v97, v97, s50, -v22
    v_mfma_f32_16x16x32_bf16 v[232:235], a[176:179], a[88:91], v[232:235]
    v_fma_f32 v98, v98, s50, -v22
    v_fma_f32 v99, v99, s50, -v22
    v_exp_f32 v96, v96
    s_waitcnt vmcnt(10)
    ds_read_b128 a[184:187], v14 offset:2048
    ds_read_b128 a[188:191], v15 offset:2048
    v_mfma_f32_16x16x32_bf16 v[236:239], a[176:179], a[92:95], v[236:239]
    v_exp_f32 v97, v97
    v_exp_f32 v98, v98
    v_exp_f32 v99, v99
    v_mfma_f32_16x16x32_bf16 v[240:243], a[176:179], a[96:99], v[240:243]
    v_fma_f32 v128, v128, s50, -v22
    v_fma_f32 v129, v129, s50, -v22
    v_mfma_f32_16x16x32_bf16 v[224:227], a[180:183], a[100:103], v[224:227]
    v_fma_f32 v130, v130, s50, -v22
    v_fma_f32 v131, v131, s50, -v22
    v_exp_f32 v128, v128
    v_mfma_f32_16x16x32_bf16 v[228:231], a[180:183], a[104:107], v[228:231]
    v_exp_f32 v129, v129
    v_exp_f32 v130, v130
    v_mfma_f32_16x16x32_bf16 v[232:235], a[180:183], a[108:111], v[232:235]
    v_exp_f32 v131, v131
    v_cvt_pk_bf16_f32 v152, v96, v97
    v_cvt_pk_bf16_f32 v153, v98, v99
    v_mfma_f32_16x16x32_bf16 v[236:239], a[180:183], a[112:115], v[236:239]
    v_add_f32 v32, v32, v96
    v_add_f32 v32, v32, v97
    v_add_f32 v32, v32, v98
    v_mfma_f32_16x16x32_bf16 v[240:243], a[180:183], a[116:119], v[240:243]
    v_add_f32 v32, v32, v99
    v_cvt_pk_bf16_f32 v154, v128, v129
    s_waitcnt lgkmcnt(0)
    v_mfma_f32_16x16x32_bf16 v[224:227], a[184:187], a[120:123], v[224:227]
    v_cvt_pk_bf16_f32 v155, v130, v131
    v_add_f32 v32, v32, v128
    v_add_f32 v32, v32, v129
    s_add_u32 m0, s48, 14336
    s_mov_b32 s47, 8192
    buffer_load_dwordx4 v8, s[32:35], s47 offen nt lds
    buffer_load_dwordx4 v9, s[32:35], s47 offen offset:1024 nt lds
    v_mfma_f32_16x16x32_bf16 v[228:231], a[184:187], a[124:127], v[228:231]
    v_add_f32 v32, v32, v130
    v_add_f32 v32, v32, v131
    ds_write_b128 v21, v[152:155] offset:5120
    v_mfma_f32_16x16x32_bf16 v[232:235], a[184:187], a[128:131], v[232:235]
    v_fma_f32 v100, v100, s50, -v24
    v_fma_f32 v101, v101, s50, -v24
    s_waitcnt vmcnt(10)
    ds_read_b128 a[192:195], v14 offset:4096
    ds_read_b128 a[196:199], v15 offset:4096
    v_mfma_f32_16x16x32_bf16 v[236:239], a[184:187], a[132:135], v[236:239]
    v_fma_f32 v102, v102, s50, -v24
    v_fma_f32 v103, v103, s50, -v24
    v_exp_f32 v100, v100
    v_mfma_f32_16x16x32_bf16 v[240:243], a[184:187], a[136:139], v[240:243]
    v_exp_f32 v101, v101
    v_exp_f32 v102, v102
    v_mfma_f32_16x16x32_bf16 v[224:227], a[188:191], a[140:143], v[224:227]
    v_exp_f32 v103, v103
    v_fma_f32 v132, v132, s50, -v24
    v_fma_f32 v133, v133, s50, -v24
    v_mfma_f32_16x16x32_bf16 v[228:231], a[188:191], a[144:147], v[228:231]
    v_fma_f32 v134, v134, s50, -v24
    v_fma_f32 v135, v135, s50, -v24
    v_exp_f32 v132, v132
    v_mfma_f32_16x16x32_bf16 v[232:235], a[188:191], a[148:151], v[232:235]
    v_exp_f32 v133, v133
    v_exp_f32 v134, v134
    v_mfma_f32_16x16x32_bf16 v[236:239], a[188:191], a[152:155], v[236:239]
    v_exp_f32 v135, v135
    v_cvt_pk_bf16_f32 v156, v100, v101
    v_cvt_pk_bf16_f32 v157, v102, v103
    v_mfma_f32_16x16x32_bf16 v[240:243], a[188:191], a[156:159], v[240:243]
    v_add_f32 v34, v34, v100
    v_add_f32 v34, v34, v101
    v_add_f32 v34, v34, v102
    s_add_u32 m0, s48, 16384
    s_mov_b32 s47, 16384
    buffer_load_dwordx4 v8, s[32:35], s47 offen nt lds
    buffer_load_dwordx4 v9, s[32:35], s47 offen offset:1024 nt lds
    s_waitcnt lgkmcnt(0)
    v_mfma_f32_16x16x32_bf16 v[84:87], a[192:195], a[0:3], 0
    v_add_f32 v34, v34, v103
    v_cvt_pk_bf16_f32 v158, v132, v133
    v_mfma_f32_16x16x32_bf16 v[88:91], a[192:195], a[4:7], 0
    v_cvt_pk_bf16_f32 v159, v134, v135
    v_add_f32 v34, v34, v132
    v_add_f32 v34, v34, v133
    v_mfma_f32_16x16x32_bf16 v[92:95], a[192:195], a[8:11], 0
    v_add_f32 v34, v34, v134
    v_add_f32 v34, v34, v135
    s_waitcnt vmcnt(10)
    ds_read_b128 a[200:203], v14 offset:6144
    ds_read_b128 a[204:207], v15 offset:6144
    v_mfma_f32_16x16x32_bf16 v[116:119], a[192:195], a[12:15], 0
    ds_write_b128 v21, v[156:159] offset:6144
    v_fma_f32 v104, v104, s50, -v26
    v_fma_f32 v105, v105, s50, -v26
    v_mfma_f32_16x16x32_bf16 v[120:123], a[192:195], a[16:19], 0
    v_fma_f32 v106, v106, s50, -v26
    v_fma_f32 v107, v107, s50, -v26
    v_max3_f32 v33, v33, v224, v225
    v_mfma_f32_16x16x32_bf16 v[84:87], a[196:199], a[20:23], v[84:87]
    v_max3_f32 v33, v33, v226, v227
    v_max3_f32 v35, v35, v228, v229
    v_mfma_f32_16x16x32_bf16 v[88:91], a[196:199], a[24:27], v[88:91]
    v_max3_f32 v35, v35, v230, v231
    v_max3_f32 v37, v37, v232, v233
    v_max3_f32 v37, v37, v234, v235
    v_mfma_f32_16x16x32_bf16 v[92:95], a[196:199], a[28:31], v[92:95]
    v_max3_f32 v39, v39, v236, v237
    v_max3_f32 v39, v39, v238, v239
    v_max3_f32 v41, v41, v240, v241
    v_mfma_f32_16x16x32_bf16 v[116:119], a[196:199], a[32:35], v[116:119]
    v_max3_f32 v41, v41, v242, v243
    v_exp_f32 v104, v104
    v_mfma_f32_16x16x32_bf16 v[120:123], a[196:199], a[36:39], v[120:123]
    v_exp_f32 v105, v105
    v_exp_f32 v106, v106
    v_exp_f32 v107, v107
    s_add_u32 m0, s48, 0
    s_mov_b32 s47, 24576
    buffer_load_dwordx4 v8, s[32:35], s47 offen nt lds
    buffer_load_dwordx4 v9, s[32:35], s47 offen offset:1024 nt lds
    s_waitcnt lgkmcnt(1)
    v_mfma_f32_16x16x32_bf16 v[84:87], a[200:203], a[40:43], v[84:87]
    v_fma_f32 v136, v136, s50, -v26
    v_fma_f32 v137, v137, s50, -v26
    v_mfma_f32_16x16x32_bf16 v[88:91], a[200:203], a[44:47], v[88:91]
    v_fma_f32 v138, v138, s50, -v26
    v_fma_f32 v139, v139, s50, -v26
    v_exp_f32 v136, v136
    v_mfma_f32_16x16x32_bf16 v[92:95], a[200:203], a[48:51], v[92:95]
    v_exp_f32 v137, v137
    v_exp_f32 v138, v138
    v_exp_f32 v139, v139
    s_waitcnt vmcnt(10)
    ds_read_b128 a[208:211], v14 offset:8192
    ds_read_b128 a[212:215], v15 offset:8192
    v_mfma_f32_16x16x32_bf16 v[116:119], a[200:203], a[52:55], v[116:119]
    v_cvt_pk_bf16_f32 v180, v104, v105
    v_cvt_pk_bf16_f32 v181, v106, v107
    v_mfma_f32_16x16x32_bf16 v[120:123], a[200:203], a[56:59], v[120:123]
    v_add_f32 v36, v36, v104
    v_add_f32 v36, v36, v105
    v_add_f32 v36, v36, v106
    v_mfma_f32_16x16x32_bf16 v[84:87], a[204:207], a[60:63], v[84:87]
    v_add_f32 v36, v36, v107
    v_cvt_pk_bf16_f32 v182, v136, v137
    v_cvt_pk_bf16_f32 v183, v138, v139
    v_mfma_f32_16x16x32_bf16 v[88:91], a[204:207], a[64:67], v[88:91]
    v_add_f32 v36, v36, v136
    v_add_f32 v36, v36, v137
    v_mfma_f32_16x16x32_bf16 v[92:95], a[204:207], a[68:71], v[92:95]
    v_add_f32 v36, v36, v138
    v_add_f32 v36, v36, v139
    ds_write_b128 v21, v[180:183] offset:7168
    v_mfma_f32_16x16x32_bf16 v[116:119], a[204:207], a[72:75], v[116:119]
    v_fma_f32 v108, v108, s50, -v28
    v_fma_f32 v109, v109, s50, -v28
    v_mfma_f32_16x16x32_bf16 v[120:123], a[204:207], a[76:79], v[120:123]
    v_fma_f32 v110, v110, s50, -v28
    v_fma_f32 v111, v111, s50, -v28
    v_exp_f32 v108, v108
    s_add_u32 m0, s48, 2048
    s_mov_b32 s47, 65536
    buffer_load_dwordx4 v8, s[32:35], s47 offen nt lds
    buffer_load_dwordx4 v9, s[32:35], s47 offen offset:1024 nt lds
    s_waitcnt lgkmcnt(1)
    v_mfma_f32_16x16x32_bf16 v[84:87], a[208:211], a[80:83], v[84:87]
    v_exp_f32 v109, v109
    v_exp_f32 v110, v110
    v_exp_f32 v111, v111
    v_mfma_f32_16x16x32_bf16 v[88:91], a[208:211], a[84:87], v[88:91]
    v_fma_f32 v140, v140, s50, -v28
    v_fma_f32 v141, v141, s50, -v28
    v_mfma_f32_16x16x32_bf16 v[92:95], a[208:211], a[88:91], v[92:95]
    v_fma_f32 v142, v142, s50, -v28
    v_fma_f32 v143, v143, s50, -v28
    v_exp_f32 v140, v140
    s_waitcnt vmcnt(10)
    ds_read_b128 a[216:219], v14 offset:10240
    ds_read_b128 a[220:223], v15 offset:10240
    v_mfma_f32_16x16x32_bf16 v[116:119], a[208:211], a[92:95], v[116:119]
    v_exp_f32 v141, v141
    v_exp_f32 v142, v142
    v_exp_f32 v143, v143
    v_mfma_f32_16x16x32_bf16 v[120:123], a[208:211], a[96:99], v[120:123]
    v_cvt_pk_bf16_f32 v148, v108, v109
    v_cvt_pk_bf16_f32 v149, v110, v111
    v_mfma_f32_16x16x32_bf16 v[84:87], a[212:215], a[100:103], v[84:87]
    v_add_f32 v38, v38, v108
    v_add_f32 v38, v38, v109
    v_add_f32 v38, v38, v110
    v_mfma_f32_16x16x32_bf16 v[88:91], a[212:215], a[104:107], v[88:91]
    v_add_f32 v38, v38, v111
    v_cvt_pk_bf16_f32 v150, v140, v141
    v_mfma_f32_16x16x32_bf16 v[92:95], a[212:215], a[108:111], v[92:95]
    v_cvt_pk_bf16_f32 v151, v142, v143
    v_add_f32 v38, v38, v140
    v_add_f32 v38, v38, v141
    v_mfma_f32_16x16x32_bf16 v[116:119], a[212:215], a[112:115], v[116:119]
    v_add_f32 v38, v38, v142
    v_add_f32 v38, v38, v143
    ds_write_b128 v21, v[148:151] offset:8192
    s_add_u32 m0, s48, 4096
    s_mov_b32 s47, 73728
    buffer_load_dwordx4 v8, s[32:35], s47 offen nt lds
    buffer_load_dwordx4 v9, s[32:35], s47 offen offset:1024 nt lds
    v_mfma_f32_16x16x32_bf16 v[120:123], a[212:215], a[116:119], v[120:123]
    v_fma_f32 v112, v112, s50, -v30
    v_fma_f32 v113, v113, s50, -v30
    s_waitcnt lgkmcnt(1)
    v_mfma_f32_16x16x32_bf16 v[84:87], a[216:219], a[120:123], v[84:87]
    v_fma_f32 v114, v114, s50, -v30
    v_fma_f32 v115, v115, s50, -v30
    v_exp_f32 v112, v112
    v_mfma_f32_16x16x32_bf16 v[88:91], a[216:219], a[124:127], v[88:91]
    v_exp_f32 v113, v113
    v_exp_f32 v114, v114
    v_exp_f32 v115, v115
    v_mfma_f32_16x16x32_bf16 v[92:95], a[216:219], a[128:131], v[92:95]
    v_fma_f32 v144, v144, s50, -v30
    v_fma_f32 v145, v145, s50, -v30
    v_mfma_f32_16x16x32_bf16 v[116:119], a[216:219], a[132:135], v[116:119]
    v_fma_f32 v146, v146, s50, -v30
    v_fma_f32 v147, v147, s50, -v30
    v_exp_f32 v144, v144
    v_mfma_f32_16x16x32_bf16 v[120:123], a[216:219], a[136:139], v[120:123]
    v_exp_f32 v145, v145
    v_exp_f32 v146, v146
    v_mfma_f32_16x16x32_bf16 v[84:87], a[220:223], a[140:143], v[84:87]
    v_exp_f32 v147, v147
    v_cvt_pk_bf16_f32 v152, v112, v113
    v_cvt_pk_bf16_f32 v153, v114, v115
    v_mfma_f32_16x16x32_bf16 v[88:91], a[220:223], a[144:147], v[88:91]
    v_add_f32 v40, v40, v112
    v_add_f32 v40, v40, v113
    v_add_f32 v40, v40, v114
    v_mfma_f32_16x16x32_bf16 v[92:95], a[220:223], a[148:151], v[92:95]
    v_add_f32 v40, v40, v115
    v_cvt_pk_bf16_f32 v154, v144, v145
    v_mfma_f32_16x16x32_bf16 v[116:119], a[220:223], a[152:155], v[116:119]
    v_cvt_pk_bf16_f32 v155, v146, v147
    v_add_f32 v40, v40, v144
    v_add_f32 v40, v40, v145
    s_add_u32 m0, s48, 6144
    s_mov_b32 s47, 81920
    buffer_load_dwordx4 v8, s[32:35], s47 offen nt lds
    buffer_load_dwordx4 v9, s[32:35], s47 offen offset:1024 nt lds
    v_mfma_f32_16x16x32_bf16 v[120:123], a[220:223], a[156:159], v[120:123]
    v_add_f32 v40, v40, v146
    v_add_f32 v40, v40, v147
    ds_write_b128 v21, v[152:155] offset:9216
    v_lshrrev_b32 v23, 9, v8
    v_and_b32 v25, 511, v8
    v_mul_u32_u24 v6, 896, v23
    v_add_u32 v6, v6, v25
    v_add_u32 v7, 6144, v6
    s_lshl_b32 s47, s40, 1
    s_add_u32 s47, s47, 8
    s_sub_u32 s47, s47, s76
    s_and_b32 s47, s47, 7
    s_mul_i32 s47, s47, 5120
    v_add_u32 v4, s47, v16
    s_lshl_b32 s47, s40, 1
    s_add_u32 s47, s47, 9
    s_sub_u32 s47, s47, s76
    s_and_b32 s47, s47, 7
    s_mul_i32 s47, s47, 5120
    v_add_u32 v5, s47, v16
    v_max3_f32 v33, v33, v84, v85
    v_max3_f32 v33, v33, v86, v87
    v_max3_f32 v35, v35, v88, v89
    v_max3_f32 v35, v35, v90, v91
    v_max3_f32 v37, v37, v92, v93
    v_max3_f32 v37, v37, v94, v95
    v_max3_f32 v39, v39, v116, v117
    v_max3_f32 v39, v39, v118, v119
    v_max3_f32 v41, v41, v120, v121
    v_max3_f32 v41, v41, v122, v123
    v_mov_b32 v23, v33
    v_mov_b32 v25, v35
    v_mov_b32 v27, v37
    v_mov_b32 v29, v39
    v_mov_b32 v31, v41
    v_permlane16_swap_b32 v33, v23
    v_permlane16_swap_b32 v35, v25
    v_permlane16_swap_b32 v37, v27
    v_permlane16_swap_b32 v39, v29
    v_permlane16_swap_b32 v41, v31
    v_max_f32 v33, v33, v23
    v_max_f32 v35, v35, v25
    v_max_f32 v37, v37, v27
    v_max_f32 v39, v39, v29
    v_max_f32 v41, v41, v31
    v_mov_b32 v23, v33
    v_mov_b32 v25, v35
    v_mov_b32 v27, v37
    v_mov_b32 v29, v39
    v_mov_b32 v31, v41
    v_permlane32_swap_b32 v33, v23
    v_permlane32_swap_b32 v35, v25
    v_permlane32_swap_b32 v37, v27
    v_permlane32_swap_b32 v39, v29
    v_permlane32_swap_b32 v41, v31
    v_max_f32 v33, v33, v23
    v_max_f32 v35, v35, v25
    v_max_f32 v37, v37, v27
    v_max_f32 v39, v39, v29
    v_max_f32 v41, v41, v31
    ds_write_b32 v19, v33 offset:4096
    ds_write_b32 v19, v35 offset:4352
    ds_write_b32 v19, v37 offset:4608
    ds_write_b32 v19, v39 offset:4864
    ds_write_b32 v19, v41 offset:5120
    s_waitcnt lgkmcnt(0)
    s_barrier
    ds_read_b128 a[0:3], v16
    ds_read_b128 a[4:7], v16 offset:1024
    ds_read_b128 a[8:11], v16 offset:2048
    ds_read_b128 a[12:15], v16 offset:3072
    ds_read_b128 a[16:19], v16 offset:4096
    s_waitcnt vmcnt(12)
    ds_read_b64_tr_b16 a[224:225], v10 offset:12288
    ds_read_b64_tr_b16 a[228:229], v11 offset:12288
    ds_read_b64_tr_b16 a[232:233], v12 offset:12288
    ds_read_b64_tr_b16 a[236:237], v13 offset:12288
    s_add_u32 m0, s48, 8192
    s_mov_b32 s47, 90112
    buffer_load_dwordx4 v8, s[32:35], s47 offen nt lds
    buffer_load_dwordx4 v9, s[32:35], s47 offen offset:1024 nt lds
    s_waitcnt vmcnt(12)
    ds_read_b64_tr_b16 a[226:227], v10 offset:14336
    ds_read_b64_tr_b16 a[230:231], v11 offset:14336
    ds_read_b64_tr_b16 a[234:235], v12 offset:14336
    ds_read_b64_tr_b16 a[238:239], v13 offset:14336
    s_waitcnt lgkmcnt(0)
    v_mfma_f32_16x16x32_bf16 v[44:47], a[224:227], a[0:3], 0
    ds_read_b128 a[20:23], v16 offset:5120
    ds_read_b128 a[24:27], v16 offset:6144
    v_mfma_f32_16x16x32_bf16 v[64:67], a[228:231], a[0:3], 0
    ds_read_b128 a[28:31], v16 offset:7168
    ds_read_b128 a[32:35], v16 offset:8192
    ds_read_b128 a[36:39], v16 offset:9216
    v_mfma_f32_16x16x32_bf16 v[96:99], a[232:235], a[0:3], 0
    ds_read_b128 v[184:187], v20 offset:4096
    ds_read_b128 v[188:191], v20 offset:4352
    ds_read_b128 v[212:215], v20 offset:4608
    v_mfma_f32_16x16x32_bf16 v[128:131], a[236:239], a[0:3], 0
    ds_read_b128 v[216:219], v20 offset:4864
    ds_read_b128 v[220:223], v20 offset:5120
    s_waitcnt lgkmcnt(0)
    v_mfma_f32_16x16x32_bf16 v[48:51], a[224:227], a[4:7], 0
    v_max3_f32 v33, v184, v185, v186
    v_max_f32 v33, v33, v187
    v_max3_f32 v35, v188, v189, v190
    v_mfma_f32_16x16x32_bf16 v[68:71], a[228:231], a[4:7], 0
    v_max_f32 v35, v35, v191
    v_max3_f32 v37, v212, v213, v214
    v_max_f32 v37, v37, v215
    v_mfma_f32_16x16x32_bf16 v[100:103], a[232:235], a[4:7], 0
    v_max3_f32 v39, v216, v217, v218
    v_max_f32 v39, v39, v219
    v_mfma_f32_16x16x32_bf16 v[132:135], a[236:239], a[4:7], 0
    v_max3_f32 v41, v220, v221, v222
    v_max_f32 v41, v41, v223
    v_mul_f32 v33, s50, v33
    s_add_u32 m0, s48, 10240
    s_mov_b32 s47, 131072
    buffer_load_dwordx4 v8, s[32:35], s47 offen nt lds
    buffer_load_dwordx4 v9, s[32:35], s47 offen offset:1024 nt lds
    v_mfma_f32_16x16x32_bf16 v[52:55], a[224:227], a[8:11], 0
    v_mul_f32 v35, s50, v35
    v_mul_f32 v37, s50, v37
    v_mul_f32 v39, s50, v39
    v_mfma_f32_16x16x32_bf16 v[72:75], a[228:231], a[8:11], 0
    s_waitcnt vmcnt(12)
    ds_read_b64_tr_b16 a[240:241], v10 offset:16384
    ds_read_b64_tr_b16 a[244:245], v11 offset:16384
    ds_read_b64_tr_b16 a[248:249], v12 offset:16384
    ds_read_b64_tr_b16 a[252:253], v13 offset:16384
    s_waitcnt vmcnt(10)
    ds_read_b64_tr_b16 a[242:243], v10
    ds_read_b64_tr_b16 a[246:247], v11
    ds_read_b64_tr_b16 a[250:251], v12
    ds_read_b64_tr_b16 a[254:255], v13
    v_mul_f32 v41, s50, v41
    v_max_f32 v33, v33, v22
    v_max_f32 v35, v35, v24
    v_mfma_f32_16x16x32_bf16 v[104:107], a[232:235], a[8:11], 0
    v_max_f32 v37, v37, v26
    v_max_f32 v39, v39, v28
    v_max_f32 v41, v41, v30
    v_mfma_f32_16x16x32_bf16 v[136:139], a[236:239], a[8:11], 0
    v_sub_f32 v22, v22, v33
    v_sub_f32 v24, v24, v35
    v_sub_f32 v26, v26, v37
    v_mfma_f32_16x16x32_bf16 v[56:59], a[224:227], a[12:15], 0
    v_sub_f32 v28, v28, v39
    v_sub_f32 v30, v30, v41
    v_exp_f32 v22, v22
    v_mfma_f32_16x16x32_bf16 v[76:79], a[228:231], a[12:15], 0
    v_exp_f32 v24, v24
    v_exp_f32 v26, v26
    v_mfma_f32_16x16x32_bf16 v[108:111], a[232:235], a[12:15], 0
    v_exp_f32 v28, v28
    v_exp_f32 v30, v30
    v_mul_f32 v32, v32, v22
    v_mfma_f32_16x16x32_bf16 v[140:143], a[236:239], a[12:15], 0
    v_mul_f32 v34, v34, v24
    v_mul_f32 v36, v36, v26
    v_mul_f32 v38, v38, v28
    s_add_u32 m0, s48, 12288
    s_mov_b32 s47, 139264
    buffer_load_dwordx4 v8, s[32:35], s47 offen nt lds
    buffer_load_dwordx4 v9, s[32:35], s47 offen offset:1024 nt lds
    v_mfma_f32_16x16x32_bf16 v[60:63], a[224:227], a[16:19], 0
    v_mul_f32 v40, v40, v30
    v_fma_f32 v160, v160, s50, -v33
    v_fma_f32 v161, v161, s50, -v33
    v_mfma_f32_16x16x32_bf16 v[80:83], a[228:231], a[16:19], 0
    v_fma_f32 v162, v162, s50, -v33
    v_fma_f32 v163, v163, s50, -v33
    v_exp_f32 v160, v160
    v_mfma_f32_16x16x32_bf16 v[112:115], a[232:235], a[16:19], 0
    v_exp_f32 v161, v161
    v_exp_f32 v162, v162
    v_exp_f32 v163, v163
    v_mfma_f32_16x16x32_bf16 v[144:147], a[236:239], a[16:19], 0
    v_fma_f32 v192, v192, s50, -v33
    v_fma_f32 v193, v193, s50, -v33
    v_fma_f32 v194, v194, s50, -v33
    s_waitcnt lgkmcnt(0)
    v_mfma_f32_16x16x32_bf16 v[44:47], a[240:243], a[20:23], v[44:47]
    ds_read_b128 a[0:3], v16 offset:10240
    ds_read_b128 a[4:7], v16 offset:11264
    v_mfma_f32_16x16x32_bf16 v[64:67], a[244:247], a[20:23], v[64:67]
    ds_read_b128 a[8:11], v16 offset:12288
    ds_read_b128 a[12:15], v16 offset:13312
    ds_read_b128 a[16:19], v16 offset:14336
    v_mfma_f32_16x16x32_bf16 v[96:99], a[248:251], a[20:23], v[96:99]
    v_fma_f32 v195, v195, s50, -v33
    v_exp_f32 v192, v192
    v_exp_f32 v193, v193
    v_mfma_f32_16x16x32_bf16 v[128:131], a[252:255], a[20:23], v[128:131]
    v_exp_f32 v194, v194
    v_exp_f32 v195, v195
    v_cvt_pk_bf16_f32 v156, v160, v161
    v_mfma_f32_16x16x32_bf16 v[48:51], a[240:243], a[24:27], v[48:51]
    v_cvt_pk_bf16_f32 v157, v162, v163
    v_add_f32 v32, v32, v160
    v_add_f32 v32, v32, v161
    s_add_u32 m0, s48, 14336
    s_mov_b32 s47, 147456
    buffer_load_dwordx4 v8, s[32:35], s47 offen nt lds
    buffer_load_dwordx4 v9, s[32:35], s47 offen offset:1024 nt lds
    v_mfma_f32_16x16x32_bf16 v[68:71], a[244:247], a[24:27], v[68:71]
    v_add_f32 v32, v32, v162
    v_add_f32 v32, v32, v163
    v_cvt_pk_bf16_f32 v158, v192, v193
    v_mfma_f32_16x16x32_bf16 v[100:103], a[248:251], a[24:27], v[100:103]
    v_cvt_pk_bf16_f32 v159, v194, v195
    v_add_f32 v32, v32, v192
    v_mfma_f32_16x16x32_bf16 v[132:135], a[252:255], a[24:27], v[132:135]
    v_add_f32 v32, v32, v193
    v_add_f32 v32, v32, v194
    v_add_f32 v32, v32, v195
    v_mfma_f32_16x16x32_bf16 v[52:55], a[240:243], a[28:31], v[52:55]
    ds_write_b128 v21, v[156:159] offset:40960
    v_fma_f32 v164, v164, s50, -v35
    v_fma_f32 v165, v165, s50, -v35
    v_mfma_f32_16x16x32_bf16 v[72:75], a[244:247], a[28:31], v[72:75]
    s_waitcnt vmcnt(12)
    ds_read_b64_tr_b16 a[40:41], v10 offset:2048
    ds_read_b64_tr_b16 a[44:45], v11 offset:2048
    ds_read_b64_tr_b16 a[48:49], v12 offset:2048
    ds_read_b64_tr_b16 a[52:53], v13 offset:2048
    s_waitcnt vmcnt(10)
    ds_read_b64_tr_b16 a[42:43], v10 offset:4096
    ds_read_b64_tr_b16 a[46:47], v11 offset:4096
    ds_read_b64_tr_b16 a[50:51], v12 offset:4096
    ds_read_b64_tr_b16 a[54:55], v13 offset:4096
    v_fma_f32 v166, v166, s50, -v35
    v_fma_f32 v167, v167, s50, -v35
    v_exp_f32 v164, v164
    v_mfma_f32_16x16x32_bf16 v[104:107], a[248:251], a[28:31], v[104:107]
    v_exp_f32 v165, v165
    v_exp_f32 v166, v166
    v_exp_f32 v167, v167
    v_mfma_f32_16x16x32_bf16 v[136:139], a[252:255], a[28:31], v[136:139]
    v_fma_f32 v196, v196, s50, -v35
    v_fma_f32 v197, v197, s50, -v35
    v_fma_f32 v198, v198, s50, -v35
    v_mfma_f32_16x16x32_bf16 v[56:59], a[240:243], a[32:35], v[56:59]
    v_fma_f32 v199, v199, s50, -v35
    v_exp_f32 v196, v196
    v_exp_f32 v197, v197
    s_add_u32 m0, s48, 16384
    s_mov_b32 s47, 155648
    buffer_load_dwordx4 v8, s[32:35], s47 offen nt lds
    buffer_load_dwordx4 v9, s[32:35], s47 offen offset:1024 nt lds
    v_mfma_f32_16x16x32_bf16 v[76:79], a[244:247], a[32:35], v[76:79]
    v_exp_f32 v198, v198
    v_exp_f32 v199, v199
    v_mfma_f32_16x16x32_bf16 v[108:111], a[248:251], a[32:35], v[108:111]
    v_cvt_pk_bf16_f32 v180, v164, v165
    v_cvt_pk_bf16_f32 v181, v166, v167
    v_add_f32 v34, v34, v164
    v_mfma_f32_16x16x32_bf16 v[140:143], a[252:255], a[32:35], v[140:143]
    v_add_f32 v34, v34, v165
    v_add_f32 v34, v34, v166
    v_add_f32 v34, v34, v167
    v_mfma_f32_16x16x32_bf16 v[60:63], a[240:243], a[36:39], v[60:63]
    v_cvt_pk_bf16_f32 v182, v196, v197
    v_cvt_pk_bf16_f32 v183, v198, v199
    v_add_f32 v34, v34, v196
    v_mfma_f32_16x16x32_bf16 v[80:83], a[244:247], a[36:39], v[80:83]
    v_add_f32 v34, v34, v197
    v_add_f32 v34, v34, v198
    v_add_f32 v34, v34, v199
    v_mfma_f32_16x16x32_bf16 v[112:115], a[248:251], a[36:39], v[112:115]
    ds_write_b128 v21, v[180:183] offset:41984
    v_fma_f32 v168, v168, s50, -v37
    v_fma_f32 v169, v169, s50, -v37
    v_mfma_f32_16x16x32_bf16 v[144:147], a[252:255], a[36:39], v[144:147]
    v_fma_f32 v170, v170, s50, -v37
    v_fma_f32 v171, v171, s50, -v37
    v_exp_f32 v168, v168
    s_waitcnt lgkmcnt(1)
    v_mfma_f32_16x16x32_bf16 v[44:47], a[40:43], a[0:3], v[44:47]
    ds_read_b128 a[20:23], v16 offset:15360
    ds_read_b128 a[24:27], v16 offset:16384
    v_mfma_f32_16x16x32_bf16 v[64:67], a[44:47], a[0:3], v[64:67]
    ds_read_b128 a[28:31], v16 offset:17408
    ds_read_b128 a[32:35], v16 offset:18432
    ds_read_b128 a[36:39], v16 offset:19456
    v_mfma_f32_16x16x32_bf16 v[96:99], a[48:51], a[0:3], v[96:99]
    v_exp_f32 v169, v169
    v_exp_f32 v170, v170
    v_exp_f32 v171, v171
    s_add_u32 m0, s48, 0
    s_mov_b32 s47, 196608
    buffer_load_dwordx4 v8, s[32:35], s47 offen nt lds
    buffer_load_dwordx4 v9, s[32:35], s47 offen offset:1024 nt lds
    v_mfma_f32_16x16x32_bf16 v[128:131], a[52:55], a[0:3], v[128:131]
    v_fma_f32 v200, v200, s50, -v37
    v_fma_f32 v201, v201, s50, -v37
    v_fma_f32 v202, v202, s50, -v37
    v_mfma_f32_16x16x32_bf16 v[48:51], a[40:43], a[4:7], v[48:51]
    v_fma_f32 v203, v203, s50, -v37
    v_exp_f32 v200, v200
    v_exp_f32 v201, v201
    v_mfma_f32_16x16x32_bf16 v[68:71], a[44:47], a[4:7], v[68:71]
    v_exp_f32 v202, v202
    v_exp_f32 v203, v203
    v_cvt_pk_bf16_f32 v148, v168, v169
    v_mfma_f32_16x16x32_bf16 v[100:103], a[48:51], a[4:7], v[100:103]
    v_cvt_pk_bf16_f32 v149, v170, v171
    v_add_f32 v36, v36, v168
    v_mfma_f32_16x16x32_bf16 v[132:135], a[52:55], a[4:7], v[132:135]
    v_add_f32 v36, v36, v169
    v_add_f32 v36, v36, v170
    v_add_f32 v36, v36, v171
    v_mfma_f32_16x16x32_bf16 v[52:55], a[40:43], a[8:11], v[52:55]
    v_cvt_pk_bf16_f32 v150, v200, v201
    v_cvt_pk_bf16_f32 v151, v202, v203
    v_add_f32 v36, v36, v200
    v_mfma_f32_16x16x32_bf16 v[72:75], a[44:47], a[8:11], v[72:75]
    s_waitcnt vmcnt(12)
    ds_read_b64_tr_b16 a[56:57], v10 offset:6144
    ds_read_b64_tr_b16 a[60:61], v11 offset:6144
    ds_read_b64_tr_b16 a[64:65], v12 offset:6144
    ds_read_b64_tr_b16 a[68:69], v13 offset:6144
    s_waitcnt vmcnt(10)
    ds_read_b64_tr_b16 a[58:59], v10 offset:8192
    ds_read_b64_tr_b16 a[62:63], v11 offset:8192
    ds_read_b64_tr_b16 a[66:67], v12 offset:8192
    ds_read_b64_tr_b16 a[70:71], v13 offset:8192
    v_add_f32 v36, v36, v201
    v_add_f32 v36, v36, v202
    v_add_f32 v36, v36, v203
    v_mfma_f32_16x16x32_bf16 v[104:107], a[48:51], a[8:11], v[104:107]
    ds_write_b128 v21, v[148:151] offset:43008
    v_fma_f32 v172, v172, s50, -v39
    v_fma_f32 v173, v173, s50, -v39
    v_mfma_f32_16x16x32_bf16 v[136:139], a[52:55], a[8:11], v[136:139]
    v_fma_f32 v174, v174, s50, -v39
    v_fma_f32 v175, v175, s50, -v39
    v_exp_f32 v172, v172
    s_add_u32 m0, s48, 2048
    s_mov_b32 s47, 204800
    buffer_load_dwordx4 v8, s[32:35], s47 offen nt lds
    buffer_load_dwordx4 v9, s[32:35], s47 offen offset:1024 nt lds
    v_mfma_f32_16x16x32_bf16 v[56:59], a[40:43], a[12:15], v[56:59]
    v_exp_f32 v173, v173
    v_exp_f32 v174, v174
    v_exp_f32 v175, v175
    v_mfma_f32_16x16x32_bf16 v[76:79], a[44:47], a[12:15], v[76:79]
    v_fma_f32 v204, v204, s50, -v39
    v_fma_f32 v205, v205, s50, -v39
    v_mfma_f32_16x16x32_bf16 v[108:111], a[48:51], a[12:15], v[108:111]
    v_fma_f32 v206, v206, s50, -v39
    v_fma_f32 v207, v207, s50, -v39
    v_exp_f32 v204, v204
    v_mfma_f32_16x16x32_bf16 v[140:143], a[52:55], a[12:15], v[140:143]
    v_exp_f32 v205, v205
    v_exp_f32 v206, v206
    v_exp_f32 v207, v207
    v_mfma_f32_16x16x32_bf16 v[60:63], a[40:43], a[16:19], v[60:63]
    v_cvt_pk_bf16_f32 v152, v172, v173
    v_cvt_pk_bf16_f32 v153, v174, v175
    v_add_f32 v38, v38, v172
    v_mfma_f32_16x16x32_bf16 v[80:83], a[44:47], a[16:19], v[80:83]
    v_add_f32 v38, v38, v173
    v_add_f32 v38, v38, v174
    v_add_f32 v38, v38, v175
    v_mfma_f32_16x16x32_bf16 v[112:115], a[48:51], a[16:19], v[112:115]
    v_cvt_pk_bf16_f32 v154, v204, v205
    v_cvt_pk_bf16_f32 v155, v206, v207
    v_add_f32 v38, v38, v204
    v_mfma_f32_16x16x32_bf16 v[144:147], a[52:55], a[16:19], v[144:147]
    v_add_f32 v38, v38, v205
    v_add_f32 v38, v38, v206
    v_add_f32 v38, v38, v207
    s_waitcnt lgkmcnt(1)
    v_mfma_f32_16x16x32_bf16 v[44:47], a[56:59], a[20:23], v[44:47]
    ds_read_b128 a[0:3], v16 offset:20480
    ds_read_b128 a[4:7], v16 offset:21504
    s_add_u32 m0, s48, 4096
    s_mov_b32 s47, 212992
    buffer_load_dwordx4 v8, s[32:35], s47 offen nt lds
    buffer_load_dwordx4 v9, s[32:35], s47 offen offset:1024 nt lds
    v_mfma_f32_16x16x32_bf16 v[64:67], a[60:63], a[20:23], v[64:67]
    ds_read_b128 a[8:11], v16 offset:22528
    ds_read_b128 a[12:15], v16 offset:23552
    ds_read_b128 a[16:19], v16 offset:24576
    v_mfma_f32_16x16x32_bf16 v[96:99], a[64:67], a[20:23], v[96:99]
    ds_write_b128 v21, v[152:155] offset:44032
    v_fma_f32 v176, v176, s50, -v41
    v_fma_f32 v177, v177, s50, -v41
    v_mfma_f32_16x16x32_bf16 v[128:131], a[68:71], a[20:23], v[128:131]
    v_fma_f32 v178, v178, s50, -v41
    v_fma_f32 v179, v179, s50, -v41
    v_exp_f32 v176, v176
    v_mfma_f32_16x16x32_bf16 v[48:51], a[56:59], a[24:27], v[48:51]
    v_exp_f32 v177, v177
    v_exp_f32 v178, v178
    v_exp_f32 v179, v179
    v_mfma_f32_16x16x32_bf16 v[68:71], a[60:63], a[24:27], v[68:71]
    v_fma_f32 v208, v208, s50, -v41
    v_fma_f32 v209, v209, s50, -v41
    v_fma_f32 v210, v210, s50, -v41
    v_mfma_f32_16x16x32_bf16 v[100:103], a[64:67], a[24:27], v[100:103]
    v_fma_f32 v211, v211, s50, -v41
    v_exp_f32 v208, v208
    v_exp_f32 v209, v209
    s_waitcnt vmcnt(12)
    v_mfma_f32_16x16x32_bf16 v[132:135], a[68:71], a[24:27], v[132:135]
    v_exp_f32 v210, v210
    v_exp_f32 v211, v211
    v_cvt_pk_bf16_f32 v156, v176, v177
    ds_read_b64_tr_b16 a[72:73], v10 offset:10240
    v_mfma_f32_16x16x32_bf16 v[52:55], a[56:59], a[28:31], v[52:55]
    v_cvt_pk_bf16_f32 v157, v178, v179
    v_add_f32 v40, v40, v176
    v_add_f32 v40, v40, v177
    ds_read_b64_tr_b16 a[76:77], v11 offset:10240
    v_mfma_f32_16x16x32_bf16 v[72:75], a[60:63], a[28:31], v[72:75]
    ds_read_b64_tr_b16 a[80:81], v12 offset:10240
    ds_read_b64_tr_b16 a[84:85], v13 offset:10240
    s_add_u32 m0, s48, 6144
    s_mov_b32 s47, 221184
    buffer_load_dwordx4 v8, s[32:35], s47 offen nt lds
    buffer_load_dwordx4 v9, s[32:35], s47 offen offset:1024 nt lds
    s_waitcnt vmcnt(12)
    ds_read_b64_tr_b16 a[74:75], v10 offset:12288
    ds_read_b64_tr_b16 a[78:79], v11 offset:12288
    ds_read_b64_tr_b16 a[82:83], v12 offset:12288
    ds_read_b64_tr_b16 a[86:87], v13 offset:12288
    v_add_f32 v40, v40, v178
    v_add_f32 v40, v40, v179
    v_cvt_pk_bf16_f32 v158, v208, v209
    v_mfma_f32_16x16x32_bf16 v[104:107], a[64:67], a[28:31], v[104:107]
    v_cvt_pk_bf16_f32 v159, v210, v211
    v_add_f32 v40, v40, v208
    v_mfma_f32_16x16x32_bf16 v[136:139], a[68:71], a[28:31], v[136:139]
    v_add_f32 v40, v40, v209
    v_add_f32 v40, v40, v210
    v_add_f32 v40, v40, v211
    v_mfma_f32_16x16x32_bf16 v[56:59], a[56:59], a[32:35], v[56:59]
    ds_write_b128 v21, v[156:159] offset:45056
    v_fma_f32 v224, v224, s50, -v33
    v_fma_f32 v225, v225, s50, -v33
    v_mfma_f32_16x16x32_bf16 v[76:79], a[60:63], a[32:35], v[76:79]
    v_fma_f32 v226, v226, s50, -v33
    v_fma_f32 v227, v227, s50, -v33
    v_exp_f32 v224, v224
    v_mfma_f32_16x16x32_bf16 v[108:111], a[64:67], a[32:35], v[108:111]
    v_exp_f32 v225, v225
    v_exp_f32 v226, v226
    v_exp_f32 v227, v227
    v_mfma_f32_16x16x32_bf16 v[140:143], a[68:71], a[32:35], v[140:143]
    v_fma_f32 v84, v84, s50, -v33
    v_fma_f32 v85, v85, s50, -v33
    v_fma_f32 v86, v86, s50, -v33
    v_mfma_f32_16x16x32_bf16 v[60:63], a[56:59], a[36:39], v[60:63]
    v_fma_f32 v87, v87, s50, -v33
    v_exp_f32 v84, v84
    v_exp_f32 v85, v85
    v_mfma_f32_16x16x32_bf16 v[80:83], a[60:63], a[36:39], v[80:83]
    v_exp_f32 v86, v86
    v_exp_f32 v87, v87
    v_cvt_pk_bf16_f32 v180, v224, v225
    s_add_u32 m0, s48, 8192
    s_mov_b32 s47, 32768
    buffer_load_dwordx4 v8, s[32:35], s47 offen nt lds
    buffer_load_dwordx4 v9, s[32:35], s47 offen offset:1024 nt lds
    v_mfma_f32_16x16x32_bf16 v[112:115], a[64:67], a[36:39], v[112:115]
    v_cvt_pk_bf16_f32 v181, v226, v227
    v_add_f32 v32, v32, v224
    v_add_f32 v32, v32, v225
    v_mfma_f32_16x16x32_bf16 v[144:147], a[68:71], a[36:39], v[144:147]
    v_add_f32 v32, v32, v226
    v_add_f32 v32, v32, v227
    v_cvt_pk_bf16_f32 v182, v84, v85
    s_waitcnt lgkmcnt(1)
    v_mfma_f32_16x16x32_bf16 v[44:47], a[72:75], a[0:3], v[44:47]
    ds_read_b128 a[20:23], v16 offset:25600
    ds_read_b128 a[24:27], v16 offset:26624
    v_mfma_f32_16x16x32_bf16 v[64:67], a[76:79], a[0:3], v[64:67]
    ds_read_b128 a[28:31], v16 offset:27648
    ds_read_b128 a[32:35], v16 offset:28672
    ds_read_b128 a[36:39], v16 offset:29696
    v_mfma_f32_16x16x32_bf16 v[96:99], a[80:83], a[0:3], v[96:99]
    v_cvt_pk_bf16_f32 v183, v86, v87
    v_add_f32 v32, v32, v84
    v_add_f32 v32, v32, v85
    v_mfma_f32_16x16x32_bf16 v[128:131], a[84:87], a[0:3], v[128:131]
    v_add_f32 v32, v32, v86
    v_add_f32 v32, v32, v87
    ds_write_b128 v21, v[180:183] offset:46080
    v_mfma_f32_16x16x32_bf16 v[48:51], a[72:75], a[4:7], v[48:51]
    v_fma_f32 v228, v228, s50, -v35
    v_fma_f32 v229, v229, s50, -v35
    v_fma_f32 v230, v230, s50, -v35
    s_waitcnt vmcnt(12)
    v_mfma_f32_16x16x32_bf16 v[68:71], a[76:79], a[4:7], v[68:71]
    v_fma_f32 v231, v231, s50, -v35
    v_exp_f32 v228, v228
    v_exp_f32 v229, v229
    ds_read_b64_tr_b16 a[88:89], v10 offset:14336
    v_mfma_f32_16x16x32_bf16 v[100:103], a[80:83], a[4:7], v[100:103]
    v_exp_f32 v230, v230
    v_exp_f32 v231, v231
    ds_read_b64_tr_b16 a[92:93], v11 offset:14336
    v_mfma_f32_16x16x32_bf16 v[132:135], a[84:87], a[4:7], v[132:135]
    v_fma_f32 v88, v88, s50, -v35
    v_fma_f32 v89, v89, s50, -v35
    v_fma_f32 v90, v90, s50, -v35
    ds_read_b64_tr_b16 a[96:97], v12 offset:14336
    v_mfma_f32_16x16x32_bf16 v[52:55], a[72:75], a[8:11], v[52:55]
    v_fma_f32 v91, v91, s50, -v35
    v_exp_f32 v88, v88
    v_exp_f32 v89, v89
    ds_read_b64_tr_b16 a[100:101], v13 offset:14336
    v_mfma_f32_16x16x32_bf16 v[72:75], a[76:79], a[8:11], v[72:75]
    s_waitcnt vmcnt(10)
    ds_read_b64_tr_b16 a[90:91], v10 offset:16384
    ds_read_b64_tr_b16 a[94:95], v11 offset:16384
    ds_read_b64_tr_b16 a[98:99], v12 offset:16384
    ds_read_b64_tr_b16 a[102:103], v13 offset:16384
    s_add_u32 m0, s48, 10240
    s_mov_b32 s47, 40960
    buffer_load_dwordx4 v8, s[32:35], s47 offen nt lds
    buffer_load_dwordx4 v9, s[32:35], s47 offen offset:1024 nt lds
    v_exp_f32 v90, v90
    v_exp_f32 v91, v91
    v_cvt_pk_bf16_f32 v148, v228, v229
    v_mfma_f32_16x16x32_bf16 v[104:107], a[80:83], a[8:11], v[104:107]
    v_cvt_pk_bf16_f32 v149, v230, v231
    v_add_f32 v34, v34, v228
    v_add_f32 v34, v34, v229
    v_mfma_f32_16x16x32_bf16 v[136:139], a[84:87], a[8:11], v[136:139]
    v_add_f32 v34, v34, v230
    v_add_f32 v34, v34, v231
    v_cvt_pk_bf16_f32 v150, v88, v89
    v_mfma_f32_16x16x32_bf16 v[56:59], a[72:75], a[12:15], v[56:59]
    v_cvt_pk_bf16_f32 v151, v90, v91
    v_add_f32 v34, v34, v88
    v_add_f32 v34, v34, v89
    v_mfma_f32_16x16x32_bf16 v[76:79], a[76:79], a[12:15], v[76:79]
    v_add_f32 v34, v34, v90
    v_add_f32 v34, v34, v91
    v_mfma_f32_16x16x32_bf16 v[108:111], a[80:83], a[12:15], v[108:111]
    ds_write_b128 v21, v[148:151] offset:47104
    v_fma_f32 v232, v232, s50, -v37
    v_fma_f32 v233, v233, s50, -v37
    v_mfma_f32_16x16x32_bf16 v[140:143], a[84:87], a[12:15], v[140:143]
    v_fma_f32 v234, v234, s50, -v37
    v_fma_f32 v235, v235, s50, -v37
    v_exp_f32 v232, v232
    s_add_u32 m0, s48, 12288
    s_mov_b32 s47, 49152
    buffer_load_dwordx4 v8, s[32:35], s47 offen nt lds
    buffer_load_dwordx4 v9, s[32:35], s47 offen offset:1024 nt lds
    v_mfma_f32_16x16x32_bf16 v[60:63], a[72:75], a[16:19], v[60:63]
    v_exp_f32 v233, v233
    v_exp_f32 v234, v234
    v_exp_f32 v235, v235
    v_mfma_f32_16x16x32_bf16 v[80:83], a[76:79], a[16:19], v[80:83]
    v_fma_f32 v92, v92, s50, -v37
    v_fma_f32 v93, v93, s50, -v37
    v_fma_f32 v94, v94, s50, -v37
    v_mfma_f32_16x16x32_bf16 v[112:115], a[80:83], a[16:19], v[112:115]
    v_fma_f32 v95, v95, s50, -v37
    v_exp_f32 v92, v92
    v_exp_f32 v93, v93
    v_mfma_f32_16x16x32_bf16 v[144:147], a[84:87], a[16:19], v[144:147]
    v_exp_f32 v94, v94
    v_exp_f32 v95, v95
    v_cvt_pk_bf16_f32 v152, v232, v233
    s_waitcnt lgkmcnt(1)
    v_mfma_f32_16x16x32_bf16 v[44:47], a[88:91], a[20:23], v[44:47]
    ds_read_b128 a[0:3], v16 offset:30720
    ds_read_b128 a[4:7], v16 offset:31744
    v_mfma_f32_16x16x32_bf16 v[64:67], a[92:95], a[20:23], v[64:67]
    ds_read_b128 a[8:11], v16 offset:32768
    ds_read_b128 a[12:15], v16 offset:33792
    ds_read_b128 a[16:19], v16 offset:34816
    s_waitcnt vmcnt(12)
    v_mfma_f32_16x16x32_bf16 v[96:99], a[96:99], a[20:23], v[96:99]
    v_cvt_pk_bf16_f32 v153, v234, v235
    v_add_f32 v36, v36, v232
    v_add_f32 v36, v36, v233
    ds_read_b64_tr_b16 a[104:105], v10
    v_mfma_f32_16x16x32_bf16 v[128:131], a[100:103], a[20:23], v[128:131]
    v_add_f32 v36, v36, v234
    v_add_f32 v36, v36, v235
    v_cvt_pk_bf16_f32 v154, v92, v93
    ds_read_b64_tr_b16 a[108:109], v11
    v_mfma_f32_16x16x32_bf16 v[48:51], a[88:91], a[24:27], v[48:51]
    v_cvt_pk_bf16_f32 v155, v94, v95
    v_add_f32 v36, v36, v92
    v_add_f32 v36, v36, v93
    ds_read_b64_tr_b16 a[112:113], v12
    v_mfma_f32_16x16x32_bf16 v[68:71], a[92:95], a[24:27], v[68:71]
    v_add_f32 v36, v36, v94
    v_add_f32 v36, v36, v95
    ds_write_b128 v21, v[152:155] offset:48128
    ds_read_b64_tr_b16 a[116:117], v13
    v_mfma_f32_16x16x32_bf16 v[100:103], a[96:99], a[24:27], v[100:103]
    v_fma_f32 v236, v236, s50, -v39
    v_fma_f32 v237, v237, s50, -v39
    s_add_u32 m0, s48, 14336
    s_mov_b32 s47, 57344
    buffer_load_dwordx4 v8, s[32:35], s47 offen nt lds
    buffer_load_dwordx4 v9, s[32:35], s47 offen offset:1024 nt lds
    v_mfma_f32_16x16x32_bf16 v[132:135], a[100:103], a[24:27], v[132:135]
    v_fma_f32 v238, v238, s50, -v39
    v_fma_f32 v239, v239, s50, -v39
    v_exp_f32 v236, v236
    v_mfma_f32_16x16x32_bf16 v[52:55], a[88:91], a[28:31], v[52:55]
    v_exp_f32 v237, v237
    v_exp_f32 v238, v238
    v_exp_f32 v239, v239
    v_mfma_f32_16x16x32_bf16 v[72:75], a[92:95], a[28:31], v[72:75]
    s_waitcnt vmcnt(12)
    ds_read_b64_tr_b16 a[106:107], v10 offset:2048
    ds_read_b64_tr_b16 a[110:111], v11 offset:2048
    ds_read_b64_tr_b16 a[114:115], v12 offset:2048
    ds_read_b64_tr_b16 a[118:119], v13 offset:2048
    v_fma_f32 v116, v116, s50, -v39
    v_fma_f32 v117, v117, s50, -v39
    v_fma_f32 v118, v118, s50, -v39
    v_mfma_f32_16x16x32_bf16 v[104:107], a[96:99], a[28:31], v[104:107]
    v_fma_f32 v119, v119, s50, -v39
    v_exp_f32 v116, v116
    v_exp_f32 v117, v117
    v_mfma_f32_16x16x32_bf16 v[136:139], a[100:103], a[28:31], v[136:139]
    v_exp_f32 v118, v118
    v_exp_f32 v119, v119
    v_cvt_pk_bf16_f32 v156, v236, v237
    v_mfma_f32_16x16x32_bf16 v[56:59], a[88:91], a[32:35], v[56:59]
    v_cvt_pk_bf16_f32 v157, v238, v239
    v_add_f32 v38, v38, v236
    v_add_f32 v38, v38, v237
    v_mfma_f32_16x16x32_bf16 v[76:79], a[92:95], a[32:35], v[76:79]
    v_add_f32 v38, v38, v238
    v_add_f32 v38, v38, v239
    s_add_u32 m0, s48, 16384
    s_mov_b32 s47, 98304
    buffer_load_dwordx4 v8, s[32:35], s47 offen nt lds
    buffer_load_dwordx4 v9, s[32:35], s47 offen offset:1024 nt lds
    v_mfma_f32_16x16x32_bf16 v[108:111], a[96:99], a[32:35], v[108:111]
    v_cvt_pk_bf16_f32 v158, v116, v117
    v_cvt_pk_bf16_f32 v159, v118, v119
    v_add_f32 v38, v38, v116
    v_mfma_f32_16x16x32_bf16 v[140:143], a[100:103], a[32:35], v[140:143]
    v_add_f32 v38, v38, v117
    v_add_f32 v38, v38, v118
    v_add_f32 v38, v38, v119
    v_mfma_f32_16x16x32_bf16 v[60:63], a[88:91], a[36:39], v[60:63]
    ds_write_b128 v21, v[156:159] offset:49152
    v_fma_f32 v240, v240, s50, -v41
    v_fma_f32 v241, v241, s50, -v41
    v_mfma_f32_16x16x32_bf16 v[80:83], a[92:95], a[36:39], v[80:83]
    v_fma_f32 v242, v242, s50, -v41
    v_fma_f32 v243, v243, s50, -v41
    v_exp_f32 v240, v240
    v_mfma_f32_16x16x32_bf16 v[112:115], a[96:99], a[36:39], v[112:115]
    v_exp_f32 v241, v241
    v_exp_f32 v242, v242
    v_exp_f32 v243, v243
    v_mfma_f32_16x16x32_bf16 v[144:147], a[100:103], a[36:39], v[144:147]
    v_fma_f32 v120, v120, s50, -v41
    v_fma_f32 v121, v121, s50, -v41
    v_fma_f32 v122, v122, s50, -v41
    s_waitcnt vmcnt(12)
    s_waitcnt lgkmcnt(1)
    v_mfma_f32_16x16x32_bf16 v[44:47], a[104:107], a[0:3], v[44:47]
    ds_read_b128 a[20:23], v16 offset:35840
    ds_read_b128 a[24:27], v16 offset:36864
    ds_read_b64_tr_b16 a[120:121], v10 offset:4096
    v_mfma_f32_16x16x32_bf16 v[64:67], a[108:111], a[0:3], v[64:67]
    ds_read_b128 a[28:31], v16 offset:37888
    ds_read_b128 a[32:35], v16 offset:38912
    ds_read_b128 a[36:39], v16 offset:39936
    ds_read_b64_tr_b16 a[124:125], v11 offset:4096
    v_mfma_f32_16x16x32_bf16 v[96:99], a[112:115], a[0:3], v[96:99]
    v_fma_f32 v123, v123, s50, -v41
    v_exp_f32 v120, v120
    v_exp_f32 v121, v121
    ds_read_b64_tr_b16 a[128:129], v12 offset:4096
    v_mfma_f32_16x16x32_bf16 v[128:131], a[116:119], a[0:3], v[128:131]
    v_exp_f32 v122, v122
    v_exp_f32 v123, v123
    v_cvt_pk_bf16_f32 v180, v240, v241
    ds_read_b64_tr_b16 a[132:133], v13 offset:4096
    v_mfma_f32_16x16x32_bf16 v[48:51], a[104:107], a[4:7], v[48:51]
    v_cvt_pk_bf16_f32 v181, v242, v243
    v_add_f32 v40, v40, v240
    v_add_f32 v40, v40, v241
    s_add_u32 m0, s48, 0
    s_mov_b32 s47, 106496
    buffer_load_dwordx4 v8, s[32:35], s47 offen nt lds
    buffer_load_dwordx4 v9, s[32:35], s47 offen offset:1024 nt lds
    v_mfma_f32_16x16x32_bf16 v[68:71], a[108:111], a[4:7], v[68:71]
    v_add_f32 v40, v40, v242
    v_add_f32 v40, v40, v243
    v_cvt_pk_bf16_f32 v182, v120, v121
    v_mfma_f32_16x16x32_bf16 v[100:103], a[112:115], a[4:7], v[100:103]
    v_cvt_pk_bf16_f32 v183, v122, v123
    v_add_f32 v40, v40, v120
    v_add_f32 v40, v40, v121
    v_mfma_f32_16x16x32_bf16 v[132:135], a[116:119], a[4:7], v[132:135]
    v_add_f32 v40, v40, v122
    v_add_f32 v40, v40, v123
    ds_write_b128 v21, v[180:183] offset:50176
    v_mfma_f32_16x16x32_bf16 v[52:55], a[104:107], a[8:11], v[52:55]
    v_mov_b32 v23, v32
    v_mov_b32 v25, v34
    v_mov_b32 v27, v36
    s_waitcnt vmcnt(12)
    v_mfma_f32_16x16x32_bf16 v[72:75], a[108:111], a[8:11], v[72:75]
    ds_read_b64_tr_b16 a[122:123], v10 offset:6144
    ds_read_b64_tr_b16 a[126:127], v11 offset:6144
    ds_read_b64_tr_b16 a[130:131], v12 offset:6144
    ds_read_b64_tr_b16 a[134:135], v13 offset:6144
    v_mov_b32 v29, v38
    v_mov_b32 v31, v40
    v_permlane16_swap_b32 v32, v23
    v_mfma_f32_16x16x32_bf16 v[104:107], a[112:115], a[8:11], v[104:107]
    v_permlane16_swap_b32 v34, v25
    v_permlane16_swap_b32 v36, v27
    v_mfma_f32_16x16x32_bf16 v[136:139], a[116:119], a[8:11], v[136:139]
    v_permlane16_swap_b32 v38, v29
    v_permlane16_swap_b32 v40, v31
    v_add_f32 v32, v32, v23
    s_add_u32 m0, s48, 2048
    s_mov_b32 s47, 114688
    buffer_load_dwordx4 v8, s[32:35], s47 offen nt lds
    buffer_load_dwordx4 v9, s[32:35], s47 offen offset:1024 nt lds
    v_mfma_f32_16x16x32_bf16 v[56:59], a[104:107], a[12:15], v[56:59]
    v_add_f32 v34, v34, v25
    v_add_f32 v36, v36, v27
    v_add_f32 v38, v38, v29
    v_mfma_f32_16x16x32_bf16 v[76:79], a[108:111], a[12:15], v[76:79]
    v_add_f32 v40, v40, v31
    v_mov_b32 v23, v32
    v_mov_b32 v25, v34
    v_mfma_f32_16x16x32_bf16 v[108:111], a[112:115], a[12:15], v[108:111]
    v_mov_b32 v27, v36
    v_mov_b32 v29, v38
    v_mov_b32 v31, v40
    v_mfma_f32_16x16x32_bf16 v[140:143], a[116:119], a[12:15], v[140:143]
    v_permlane32_swap_b32 v32, v23
    v_permlane32_swap_b32 v34, v25
    v_permlane32_swap_b32 v36, v27
    v_mfma_f32_16x16x32_bf16 v[60:63], a[104:107], a[16:19], v[60:63]
    v_permlane32_swap_b32 v38, v29
    v_permlane32_swap_b32 v40, v31
    v_add_f32 v32, v32, v23
    v_mfma_f32_16x16x32_bf16 v[80:83], a[108:111], a[16:19], v[80:83]
    v_add_f32 v34, v34, v25
    v_add_f32 v36, v36, v27
    v_add_f32 v38, v38, v29
    v_mfma_f32_16x16x32_bf16 v[112:115], a[112:115], a[16:19], v[112:115]
    v_add_f32 v40, v40, v31
    ds_write_b32 v19, v32 offset:2048
    ds_write_b32 v19, v34 offset:2304
    s_waitcnt vmcnt(12)
    v_mfma_f32_16x16x32_bf16 v[144:147], a[116:119], a[16:19], v[144:147]
    ds_write_b32 v19, v36 offset:2560
    ds_write_b32 v19, v38 offset:2816
    ds_write_b32 v19, v40 offset:3072
    ds_read_b64_tr_b16 a[136:137], v10 offset:8192
    s_waitcnt lgkmcnt(6)
    v_mfma_f32_16x16x32_bf16 v[44:47], a[120:123], a[20:23], v[44:47]
    ds_read_b64_tr_b16 a[140:141], v11 offset:8192
    v_mfma_f32_16x16x32_bf16 v[64:67], a[124:127], a[20:23], v[64:67]
    s_waitcnt lgkmcnt(0)
    s_barrier
    ds_read_b64_tr_b16 a[144:145], v12 offset:8192
    v_mfma_f32_16x16x32_bf16 v[96:99], a[128:131], a[20:23], v[96:99]
    ds_read_b128 a[0:3], v17
    ds_read_b64_tr_b16 a[148:149], v13 offset:8192
    v_mfma_f32_16x16x32_bf16 v[128:131], a[132:135], a[20:23], v[128:131]
    v_mul_f32 v44, v44, v22
    v_mul_f32 v45, v45, v22
    v_mul_f32 v46, v46, v22
    v_mul_f32 v47, v47, v22
    ds_read_b128 a[4:7], v17 offset:1024
    s_add_u32 m0, s48, 4096
    s_mov_b32 s47, 122880
    buffer_load_dwordx4 v8, s[32:35], s47 offen nt lds
    buffer_load_dwordx4 v9, s[32:35], s47 offen offset:1024 nt lds
    v_mfma_f32_16x16x32_bf16 v[48:51], a[120:123], a[24:27], v[48:51]
    v_mul_f32 v64, v64, v22
    v_mul_f32 v65, v65, v22
    v_mul_f32 v66, v66, v22
    v_mul_f32 v67, v67, v22
    ds_read_b128 a[8:11], v17 offset:2048
    v_mfma_f32_16x16x32_bf16 v[68:71], a[124:127], a[24:27], v[68:71]
    v_mul_f32 v96, v96, v22
    v_mul_f32 v97, v97, v22
    v_mul_f32 v98, v98, v22
    v_mul_f32 v99, v99, v22
    v_mfma_f32_16x16x32_bf16 v[100:103], a[128:131], a[24:27], v[100:103]
    v_mul_f32 v128, v128, v22
    v_mul_f32 v129, v129, v22
    v_mul_f32 v130, v130, v22
    v_mul_f32 v131, v131, v22
    ds_read_b128 a[12:15], v17 offset:3072
    v_mfma_f32_16x16x32_bf16 v[132:135], a[132:135], a[24:27], v[132:135]
    v_mul_f32 v48, v48, v24
    v_mul_f32 v49, v49, v24
    v_mul_f32 v50, v50, v24
    v_mul_f32 v51, v51, v24
    ds_read_b128 a[16:19], v17 offset:4096
    v_mfma_f32_16x16x32_bf16 v[52:55], a[120:123], a[28:31], v[52:55]
    v_mul_f32 v68, v68, v24
    v_mul_f32 v69, v69, v24
    v_mul_f32 v70, v70, v24
    v_mul_f32 v71, v71, v24
    s_waitcnt vmcnt(12)
    v_mfma_f32_16x16x32_bf16 v[72:75], a[124:127], a[28:31], v[72:75]
    ds_read_b64_tr_b16 a[138:139], v10 offset:10240
    ds_read_b64_tr_b16 a[142:143], v11 offset:10240
    ds_read_b64_tr_b16 a[146:147], v12 offset:10240
    ds_read_b64_tr_b16 a[150:151], v13 offset:10240
    v_mul_f32 v100, v100, v24
    v_mul_f32 v101, v101, v24
    v_mul_f32 v102, v102, v24
    v_mul_f32 v103, v103, v24
    v_mfma_f32_16x16x32_bf16 v[104:107], a[128:131], a[28:31], v[104:107]
    v_mul_f32 v132, v132, v24
    v_mul_f32 v133, v133, v24
    v_mul_f32 v134, v134, v24
    v_mul_f32 v135, v135, v24
    s_add_u32 m0, s48, 6144
    s_mov_b32 s47, 163840
    buffer_load_dwordx4 v8, s[32:35], s47 offen nt lds
    buffer_load_dwordx4 v9, s[32:35], s47 offen offset:1024 nt lds
    v_mfma_f32_16x16x32_bf16 v[136:139], a[132:135], a[28:31], v[136:139]
    v_mul_f32 v52, v52, v26
    v_mul_f32 v53, v53, v26
    v_mul_f32 v54, v54, v26
    v_mul_f32 v55, v55, v26
    v_mfma_f32_16x16x32_bf16 v[56:59], a[120:123], a[32:35], v[56:59]
    v_mul_f32 v72, v72, v26
    v_mul_f32 v73, v73, v26
    v_mul_f32 v74, v74, v26
    v_mul_f32 v75, v75, v26
    v_mfma_f32_16x16x32_bf16 v[76:79], a[124:127], a[32:35], v[76:79]
    v_mul_f32 v104, v104, v26
    v_mul_f32 v105, v105, v26
    v_mul_f32 v106, v106, v26
    v_mul_f32 v107, v107, v26
    v_mfma_f32_16x16x32_bf16 v[108:111], a[128:131], a[32:35], v[108:111]
    v_mul_f32 v136, v136, v26
    v_mul_f32 v137, v137, v26
    v_mul_f32 v138, v138, v26
    v_mul_f32 v139, v139, v26
    v_mfma_f32_16x16x32_bf16 v[140:143], a[132:135], a[32:35], v[140:143]
    v_mul_f32 v56, v56, v28
    v_mul_f32 v57, v57, v28
    v_mul_f32 v58, v58, v28
    v_mul_f32 v59, v59, v28
    v_mfma_f32_16x16x32_bf16 v[60:63], a[120:123], a[36:39], v[60:63]
    v_mul_f32 v76, v76, v28
    v_mul_f32 v77, v77, v28
    v_mul_f32 v78, v78, v28
    v_mul_f32 v79, v79, v28
    s_waitcnt vmcnt(12)
    v_mfma_f32_16x16x32_bf16 v[80:83], a[124:127], a[36:39], v[80:83]
    v_mul_f32 v108, v108, v28
    v_mul_f32 v109, v109, v28
    v_mul_f32 v110, v110, v28
    v_mul_f32 v111, v111, v28
    ds_read_b64_tr_b16 a[152:153], v10 offset:12288
    v_mfma_f32_16x16x32_bf16 v[112:115], a[128:131], a[36:39], v[112:115]
    v_mul_f32 v140, v140, v28
    v_mul_f32 v141, v141, v28
    v_mul_f32 v142, v142, v28
    v_mul_f32 v143, v143, v28
    ds_read_b64_tr_b16 a[156:157], v11 offset:12288
    v_mfma_f32_16x16x32_bf16 v[144:147], a[132:135], a[36:39], v[144:147]
    v_mul_f32 v60, v60, v30
    v_mul_f32 v61, v61, v30
    v_mul_f32 v62, v62, v30
    v_mul_f32 v63, v63, v30
    ds_read_b64_tr_b16 a[160:161], v12 offset:12288
    v_mul_f32 v80, v80, v30
    v_mul_f32 v81, v81, v30
    v_mul_f32 v82, v82, v30
    v_mul_f32 v83, v83, v30
    v_mul_f32 v112, v112, v30
    v_mul_f32 v113, v113, v30
    v_mul_f32 v114, v114, v30
    v_mul_f32 v115, v115, v30
    v_mul_f32 v144, v144, v30
    v_mul_f32 v145, v145, v30
    v_mul_f32 v146, v146, v30
    v_mul_f32 v147, v147, v30
    s_waitcnt lgkmcnt(3)
    v_mfma_f32_16x16x32_bf16 v[44:47], a[136:139], a[0:3], v[44:47]
    ds_read_b64_tr_b16 a[164:165], v13 offset:12288
    s_add_u32 m0, s48, 8192
    s_mov_b32 s47, 172032
    buffer_load_dwordx4 v8, s[32:35], s47 offen nt lds
    buffer_load_dwordx4 v9, s[32:35], s47 offen offset:1024 nt lds
    v_mfma_f32_16x16x32_bf16 v[64:67], a[140:143], a[0:3], v[64:67]
    ds_read_b128 a[20:23], v17 offset:5120
    v_mfma_f32_16x16x32_bf16 v[96:99], a[144:147], a[0:3], v[96:99]
    ds_read_b128 a[24:27], v17 offset:6144
    v_mfma_f32_16x16x32_bf16 v[128:131], a[148:151], a[0:3], v[128:131]
    ds_read_b128 a[28:31], v17 offset:7168
    v_mfma_f32_16x16x32_bf16 v[48:51], a[136:139], a[4:7], v[48:51]
    v_mfma_f32_16x16x32_bf16 v[68:71], a[140:143], a[4:7], v[68:71]
    ds_read_b128 a[32:35], v17 offset:8192
    s_waitcnt vmcnt(12)
    v_mfma_f32_16x16x32_bf16 v[100:103], a[144:147], a[4:7], v[100:103]
    ds_read_b128 a[36:39], v17 offset:9216
    ds_read_b64_tr_b16 a[154:155], v10 offset:14336
    v_mfma_f32_16x16x32_bf16 v[132:135], a[148:151], a[4:7], v[132:135]
    ds_read_b64_tr_b16 a[158:159], v11 offset:14336
    ds_read_b64_tr_b16 a[162:163], v12 offset:14336
    v_mfma_f32_16x16x32_bf16 v[52:55], a[136:139], a[8:11], v[52:55]
    ds_read_b64_tr_b16 a[166:167], v13 offset:14336
    v_mfma_f32_16x16x32_bf16 v[72:75], a[140:143], a[8:11], v[72:75]
    v_mfma_f32_16x16x32_bf16 v[104:107], a[144:147], a[8:11], v[104:107]
    s_add_u32 m0, s48, 10240
    s_mov_b32 s47, 180224
    buffer_load_dwordx4 v8, s[32:35], s47 offen nt lds
    buffer_load_dwordx4 v9, s[32:35], s47 offen offset:1024 nt lds
    v_mfma_f32_16x16x32_bf16 v[136:139], a[148:151], a[8:11], v[136:139]
    v_mfma_f32_16x16x32_bf16 v[56:59], a[136:139], a[12:15], v[56:59]
    v_mfma_f32_16x16x32_bf16 v[76:79], a[140:143], a[12:15], v[76:79]
    v_mfma_f32_16x16x32_bf16 v[108:111], a[144:147], a[12:15], v[108:111]
    v_mfma_f32_16x16x32_bf16 v[140:143], a[148:151], a[12:15], v[140:143]
    v_mfma_f32_16x16x32_bf16 v[60:63], a[136:139], a[16:19], v[60:63]
    v_mfma_f32_16x16x32_bf16 v[80:83], a[140:143], a[16:19], v[80:83]
    v_mfma_f32_16x16x32_bf16 v[112:115], a[144:147], a[16:19], v[112:115]
    v_mfma_f32_16x16x32_bf16 v[144:147], a[148:151], a[16:19], v[144:147]
    s_waitcnt vmcnt(12)
    ds_read_b64_tr_b16 a[168:169], v10 offset:16384
    s_waitcnt lgkmcnt(1)
    v_mfma_f32_16x16x32_bf16 v[44:47], a[152:155], a[20:23], v[44:47]
    ds_read_b64_tr_b16 a[172:173], v11 offset:16384
    ds_read_b64_tr_b16 a[176:177], v12 offset:16384
    v_mfma_f32_16x16x32_bf16 v[64:67], a[156:159], a[20:23], v[64:67]
    ds_read_b128 a[0:3], v17 offset:10240
    ds_read_b64_tr_b16 a[180:181], v13 offset:16384
    v_mfma_f32_16x16x32_bf16 v[96:99], a[160:163], a[20:23], v[96:99]
    ds_read_b128 a[4:7], v17 offset:11264
    v_mfma_f32_16x16x32_bf16 v[128:131], a[164:167], a[20:23], v[128:131]
    ds_read_b128 a[8:11], v17 offset:12288
    v_mfma_f32_16x16x32_bf16 v[48:51], a[152:155], a[24:27], v[48:51]
    s_add_u32 m0, s48, 12288
    s_mov_b32 s47, 188416
    buffer_load_dwordx4 v8, s[32:35], s47 offen nt lds
    buffer_load_dwordx4 v9, s[32:35], s47 offen offset:1024 nt lds
    v_mfma_f32_16x16x32_bf16 v[68:71], a[156:159], a[24:27], v[68:71]
    ds_read_b128 a[12:15], v17 offset:13312
    v_mfma_f32_16x16x32_bf16 v[100:103], a[160:163], a[24:27], v[100:103]
    ds_read_b128 a[16:19], v17 offset:14336
    v_mfma_f32_16x16x32_bf16 v[132:135], a[164:167], a[24:27], v[132:135]
    v_mfma_f32_16x16x32_bf16 v[52:55], a[152:155], a[28:31], v[52:55]
    v_mfma_f32_16x16x32_bf16 v[72:75], a[156:159], a[28:31], v[72:75]
    s_waitcnt vmcnt(12)
    ds_read_b64_tr_b16 a[170:171], v10
    ds_read_b64_tr_b16 a[174:175], v11
    ds_read_b64_tr_b16 a[178:179], v12
    ds_read_b64_tr_b16 a[182:183], v13
    v_mfma_f32_16x16x32_bf16 v[104:107], a[160:163], a[28:31], v[104:107]
    v_mfma_f32_16x16x32_bf16 v[136:139], a[164:167], a[28:31], v[136:139]
    v_mfma_f32_16x16x32_bf16 v[56:59], a[152:155], a[32:35], v[56:59]
    v_mfma_f32_16x16x32_bf16 v[76:79], a[156:159], a[32:35], v[76:79]
    v_mfma_f32_16x16x32_bf16 v[108:111], a[160:163], a[32:35], v[108:111]
    v_mfma_f32_16x16x32_bf16 v[140:143], a[164:167], a[32:35], v[140:143]
    v_mfma_f32_16x16x32_bf16 v[60:63], a[152:155], a[36:39], v[60:63]
    v_mfma_f32_16x16x32_bf16 v[80:83], a[156:159], a[36:39], v[80:83]
    s_add_u32 m0, s48, 14336
    s_mov_b32 s47, 229376
    buffer_load_dwordx4 v8, s[32:35], s47 offen nt lds
    buffer_load_dwordx4 v9, s[32:35], s47 offen offset:1024 nt lds
    v_mfma_f32_16x16x32_bf16 v[112:115], a[160:163], a[36:39], v[112:115]
    v_mfma_f32_16x16x32_bf16 v[144:147], a[164:167], a[36:39], v[144:147]
    s_waitcnt lgkmcnt(0)
    v_mfma_f32_16x16x32_bf16 v[44:47], a[168:171], a[0:3], v[44:47]
    v_mfma_f32_16x16x32_bf16 v[64:67], a[172:175], a[0:3], v[64:67]
    ds_read_b128 a[20:23], v17 offset:15360
    v_mfma_f32_16x16x32_bf16 v[96:99], a[176:179], a[0:3], v[96:99]
    ds_read_b128 a[24:27], v17 offset:16384
    v_mfma_f32_16x16x32_bf16 v[128:131], a[180:183], a[0:3], v[128:131]
    ds_read_b128 a[28:31], v17 offset:17408
    v_mfma_f32_16x16x32_bf16 v[48:51], a[168:171], a[4:7], v[48:51]
    v_mfma_f32_16x16x32_bf16 v[68:71], a[172:175], a[4:7], v[68:71]
    ds_read_b128 a[32:35], v17 offset:18432
    v_mfma_f32_16x16x32_bf16 v[100:103], a[176:179], a[4:7], v[100:103]
    ds_read_b128 a[36:39], v17 offset:19456
    s_waitcnt vmcnt(12)
    v_mfma_f32_16x16x32_bf16 v[132:135], a[180:183], a[4:7], v[132:135]
    ds_read_b64_tr_b16 a[184:185], v10 offset:2048
    ds_read_b64_tr_b16 a[188:189], v11 offset:2048
    v_mfma_f32_16x16x32_bf16 v[52:55], a[168:171], a[8:11], v[52:55]
    ds_read_b64_tr_b16 a[192:193], v12 offset:2048
    ds_read_b64_tr_b16 a[196:197], v13 offset:2048
    v_mfma_f32_16x16x32_bf16 v[72:75], a[172:175], a[8:11], v[72:75]
    s_waitcnt vmcnt(10)
    ds_read_b64_tr_b16 a[186:187], v10 offset:4096
    ds_read_b64_tr_b16 a[190:191], v11 offset:4096
    ds_read_b64_tr_b16 a[194:195], v12 offset:4096
    ds_read_b64_tr_b16 a[198:199], v13 offset:4096
    v_mfma_f32_16x16x32_bf16 v[104:107], a[176:179], a[8:11], v[104:107]
    s_add_u32 m0, s48, 16384
    s_mov_b32 s47, 237568
    buffer_load_dwordx4 v8, s[32:35], s47 offen nt lds
    buffer_load_dwordx4 v9, s[32:35], s47 offen offset:1024 nt lds
    v_mfma_f32_16x16x32_bf16 v[136:139], a[180:183], a[8:11], v[136:139]
    v_mfma_f32_16x16x32_bf16 v[56:59], a[168:171], a[12:15], v[56:59]
    v_mfma_f32_16x16x32_bf16 v[76:79], a[172:175], a[12:15], v[76:79]
    v_mfma_f32_16x16x32_bf16 v[108:111], a[176:179], a[12:15], v[108:111]
    v_mfma_f32_16x16x32_bf16 v[140:143], a[180:183], a[12:15], v[140:143]
    v_mfma_f32_16x16x32_bf16 v[60:63], a[168:171], a[16:19], v[60:63]
    v_mfma_f32_16x16x32_bf16 v[80:83], a[172:175], a[16:19], v[80:83]
    v_mfma_f32_16x16x32_bf16 v[112:115], a[176:179], a[16:19], v[112:115]
    v_mfma_f32_16x16x32_bf16 v[144:147], a[180:183], a[16:19], v[144:147]
    s_waitcnt lgkmcnt(0)
    v_mfma_f32_16x16x32_bf16 v[44:47], a[184:187], a[20:23], v[44:47]
    v_mfma_f32_16x16x32_bf16 v[64:67], a[188:191], a[20:23], v[64:67]
    ds_read_b128 a[0:3], v17 offset:20480
    v_mfma_f32_16x16x32_bf16 v[96:99], a[192:195], a[20:23], v[96:99]
    ds_read_b128 a[4:7], v17 offset:21504
    v_mfma_f32_16x16x32_bf16 v[128:131], a[196:199], a[20:23], v[128:131]
    ds_read_b128 a[8:11], v17 offset:22528
    v_mfma_f32_16x16x32_bf16 v[48:51], a[184:187], a[24:27], v[48:51]
    s_add_u32 m0, s48, 0
    s_mov_b32 s47, 245760
    buffer_load_dwordx4 v8, s[32:35], s47 offen nt lds
    buffer_load_dwordx4 v9, s[32:35], s47 offen offset:1024 nt lds
    v_mfma_f32_16x16x32_bf16 v[68:71], a[188:191], a[24:27], v[68:71]
    ds_read_b128 a[12:15], v17 offset:23552
    v_mfma_f32_16x16x32_bf16 v[100:103], a[192:195], a[24:27], v[100:103]
    ds_read_b128 a[16:19], v17 offset:24576
    v_mfma_f32_16x16x32_bf16 v[132:135], a[196:199], a[24:27], v[132:135]
    v_mfma_f32_16x16x32_bf16 v[52:55], a[184:187], a[28:31], v[52:55]
    v_mfma_f32_16x16x32_bf16 v[72:75], a[188:191], a[28:31], v[72:75]
    s_waitcnt vmcnt(12)
    ds_read_b64_tr_b16 a[200:201], v10 offset:6144
    ds_read_b64_tr_b16 a[204:205], v11 offset:6144
    ds_read_b64_tr_b16 a[208:209], v12 offset:6144
    ds_read_b64_tr_b16 a[212:213], v13 offset:6144
    s_waitcnt vmcnt(10)
    ds_read_b64_tr_b16 a[202:203], v10 offset:8192
    ds_read_b64_tr_b16 a[206:207], v11 offset:8192
    ds_read_b64_tr_b16 a[210:211], v12 offset:8192
    ds_read_b64_tr_b16 a[214:215], v13 offset:8192
    v_mfma_f32_16x16x32_bf16 v[104:107], a[192:195], a[28:31], v[104:107]
    v_mfma_f32_16x16x32_bf16 v[136:139], a[196:199], a[28:31], v[136:139]
    v_mfma_f32_16x16x32_bf16 v[56:59], a[184:187], a[32:35], v[56:59]
    v_mfma_f32_16x16x32_bf16 v[76:79], a[188:191], a[32:35], v[76:79]
    v_mfma_f32_16x16x32_bf16 v[108:111], a[192:195], a[32:35], v[108:111]
    v_mfma_f32_16x16x32_bf16 v[140:143], a[196:199], a[32:35], v[140:143]
    v_mfma_f32_16x16x32_bf16 v[60:63], a[184:187], a[36:39], v[60:63]
    s_add_u32 m0, s48, 2048
    s_mov_b32 s47, 253952
    buffer_load_dwordx4 v8, s[32:35], s47 offen nt lds
    buffer_load_dwordx4 v9, s[32:35], s47 offen offset:1024 nt lds
    v_mfma_f32_16x16x32_bf16 v[80:83], a[188:191], a[36:39], v[80:83]
    v_mfma_f32_16x16x32_bf16 v[112:115], a[192:195], a[36:39], v[112:115]
    v_mfma_f32_16x16x32_bf16 v[144:147], a[196:199], a[36:39], v[144:147]
    s_waitcnt lgkmcnt(0)
    v_mfma_f32_16x16x32_bf16 v[44:47], a[200:203], a[0:3], v[44:47]
    v_mfma_f32_16x16x32_bf16 v[64:67], a[204:207], a[0:3], v[64:67]
    ds_read_b128 a[20:23], v17 offset:25600
    v_mfma_f32_16x16x32_bf16 v[96:99], a[208:211], a[0:3], v[96:99]
    ds_read_b128 a[24:27], v17 offset:26624
    v_mfma_f32_16x16x32_bf16 v[128:131], a[212:215], a[0:3], v[128:131]
    ds_read_b128 a[28:31], v17 offset:27648
    v_mfma_f32_16x16x32_bf16 v[48:51], a[200:203], a[4:7], v[48:51]
    v_mfma_f32_16x16x32_bf16 v[68:71], a[204:207], a[4:7], v[68:71]
    ds_read_b128 a[32:35], v17 offset:28672
    v_mfma_f32_16x16x32_bf16 v[100:103], a[208:211], a[4:7], v[100:103]
    ds_read_b128 a[36:39], v17 offset:29696
    v_mfma_f32_16x16x32_bf16 v[132:135], a[212:215], a[4:7], v[132:135]
    v_mfma_f32_16x16x32_bf16 v[52:55], a[200:203], a[8:11], v[52:55]
    v_mfma_f32_16x16x32_bf16 v[72:75], a[204:207], a[8:11], v[72:75]
    s_waitcnt vmcnt(10)
    ds_read_b64_tr_b16 a[224:225], v10 offset:10240
    ds_read_b64_tr_b16 a[228:229], v11 offset:10240
    ds_read_b64_tr_b16 a[232:233], v12 offset:10240
    ds_read_b64_tr_b16 a[236:237], v13 offset:10240
    s_add_u32 m0, s48, 4096
    s_add_u32 s47, s68, 0
    buffer_load_dwordx4 v6, s[56:59], s47 offen lds
    buffer_load_dwordx4 v7, s[56:59], s47 offen offset:1024 lds
    s_waitcnt vmcnt(10)
    ds_read_b64_tr_b16 a[226:227], v10 offset:12288
    ds_read_b64_tr_b16 a[230:231], v11 offset:12288
    ds_read_b64_tr_b16 a[234:235], v12 offset:12288
    ds_read_b64_tr_b16 a[238:239], v13 offset:12288
    v_mfma_f32_16x16x32_bf16 v[104:107], a[208:211], a[8:11], v[104:107]
    v_mfma_f32_16x16x32_bf16 v[136:139], a[212:215], a[8:11], v[136:139]
    v_mfma_f32_16x16x32_bf16 v[56:59], a[200:203], a[12:15], v[56:59]
    v_mfma_f32_16x16x32_bf16 v[76:79], a[204:207], a[12:15], v[76:79]
    v_mfma_f32_16x16x32_bf16 v[108:111], a[208:211], a[12:15], v[108:111]
    v_mfma_f32_16x16x32_bf16 v[140:143], a[212:215], a[12:15], v[140:143]
    v_mfma_f32_16x16x32_bf16 v[60:63], a[200:203], a[16:19], v[60:63]
    v_mfma_f32_16x16x32_bf16 v[80:83], a[204:207], a[16:19], v[80:83]
    v_mfma_f32_16x16x32_bf16 v[112:115], a[208:211], a[16:19], v[112:115]
    v_mfma_f32_16x16x32_bf16 v[144:147], a[212:215], a[16:19], v[144:147]
    s_waitcnt lgkmcnt(0)
    v_mfma_f32_16x16x32_bf16 v[44:47], a[224:227], a[20:23], v[44:47]
    v_mfma_f32_16x16x32_bf16 v[64:67], a[228:231], a[20:23], v[64:67]
    ds_read_b128 a[0:3], v17 offset:30720
    v_mfma_f32_16x16x32_bf16 v[96:99], a[232:235], a[20:23], v[96:99]
    ds_read_b128 a[4:7], v17 offset:31744
    s_add_u32 m0, s48, 6144
    s_add_u32 s47, s68, 14336
    buffer_load_dwordx4 v6, s[56:59], s47 offen lds
    buffer_load_dwordx4 v7, s[56:59], s47 offen offset:1024 lds
    v_mfma_f32_16x16x32_bf16 v[128:131], a[236:239], a[20:23], v[128:131]
    ds_read_b128 a[8:11], v17 offset:32768
    v_mfma_f32_16x16x32_bf16 v[48:51], a[224:227], a[24:27], v[48:51]
    v_mfma_f32_16x16x32_bf16 v[68:71], a[228:231], a[24:27], v[68:71]
    ds_read_b128 a[12:15], v17 offset:33792
    v_mfma_f32_16x16x32_bf16 v[100:103], a[232:235], a[24:27], v[100:103]
    ds_read_b128 a[16:19], v17 offset:34816
    v_mfma_f32_16x16x32_bf16 v[132:135], a[236:239], a[24:27], v[132:135]
    v_mfma_f32_16x16x32_bf16 v[52:55], a[224:227], a[28:31], v[52:55]
    v_mfma_f32_16x16x32_bf16 v[72:75], a[228:231], a[28:31], v[72:75]
    s_waitcnt vmcnt(10)
    ds_read_b64_tr_b16 a[240:241], v10 offset:14336
    ds_read_b64_tr_b16 a[244:245], v11 offset:14336
    ds_read_b64_tr_b16 a[248:249], v12 offset:14336
    ds_read_b64_tr_b16 a[252:253], v13 offset:14336
    s_waitcnt vmcnt(8)
    ds_read_b64_tr_b16 a[242:243], v10 offset:16384
    ds_read_b64_tr_b16 a[246:247], v11 offset:16384
    ds_read_b64_tr_b16 a[250:251], v12 offset:16384
    ds_read_b64_tr_b16 a[254:255], v13 offset:16384
    s_add_u32 m0, s48, 8192
    s_add_u32 s47, s69, 0
    buffer_load_dwordx4 v6, s[56:59], s47 offen lds
    buffer_load_dwordx4 v7, s[56:59], s47 offen offset:1024 lds
    v_mfma_f32_16x16x32_bf16 v[104:107], a[232:235], a[28:31], v[104:107]
    v_mfma_f32_16x16x32_bf16 v[136:139], a[236:239], a[28:31], v[136:139]
    v_mfma_f32_16x16x32_bf16 v[56:59], a[224:227], a[32:35], v[56:59]
    v_mfma_f32_16x16x32_bf16 v[76:79], a[228:231], a[32:35], v[76:79]
    v_mfma_f32_16x16x32_bf16 v[108:111], a[232:235], a[32:35], v[108:111]
    v_mfma_f32_16x16x32_bf16 v[140:143], a[236:239], a[32:35], v[140:143]
    v_mfma_f32_16x16x32_bf16 v[60:63], a[224:227], a[36:39], v[60:63]
    v_mfma_f32_16x16x32_bf16 v[80:83], a[228:231], a[36:39], v[80:83]
    v_mfma_f32_16x16x32_bf16 v[112:115], a[232:235], a[36:39], v[112:115]
    v_mfma_f32_16x16x32_bf16 v[144:147], a[236:239], a[36:39], v[144:147]
    s_waitcnt lgkmcnt(0)
    v_mfma_f32_16x16x32_bf16 v[44:47], a[240:243], a[0:3], v[44:47]
    ds_read_b128 a[20:23], v17 offset:35840
    v_mfma_f32_16x16x32_bf16 v[64:67], a[244:247], a[0:3], v[64:67]
    ds_read_b128 a[24:27], v17 offset:36864
    v_mfma_f32_16x16x32_bf16 v[96:99], a[248:251], a[0:3], v[96:99]
    ds_read_b128 a[28:31], v17 offset:37888
    s_add_u32 m0, s48, 10240
    s_add_u32 s47, s69, 14336
    buffer_load_dwordx4 v6, s[56:59], s47 offen lds
    buffer_load_dwordx4 v7, s[56:59], s47 offen offset:1024 lds
    v_mfma_f32_16x16x32_bf16 v[128:131], a[252:255], a[0:3], v[128:131]
    ds_read_b128 a[32:35], v17 offset:38912
    v_mfma_f32_16x16x32_bf16 v[48:51], a[240:243], a[4:7], v[48:51]
    ds_read_b128 a[36:39], v17 offset:39936
    v_mfma_f32_16x16x32_bf16 v[68:71], a[244:247], a[4:7], v[68:71]
    v_mfma_f32_16x16x32_bf16 v[100:103], a[248:251], a[4:7], v[100:103]
    v_mfma_f32_16x16x32_bf16 v[132:135], a[252:255], a[4:7], v[132:135]
    v_mfma_f32_16x16x32_bf16 v[52:55], a[240:243], a[8:11], v[52:55]
    v_mfma_f32_16x16x32_bf16 v[72:75], a[244:247], a[8:11], v[72:75]
    s_waitcnt vmcnt(10)
    ds_read_b64_tr_b16 a[40:41], v10
    ds_read_b64_tr_b16 a[44:45], v11
    ds_read_b64_tr_b16 a[48:49], v12
    ds_read_b64_tr_b16 a[52:53], v13
    s_waitcnt vmcnt(8)
    ds_read_b64_tr_b16 a[42:43], v10 offset:2048
    ds_read_b64_tr_b16 a[46:47], v11 offset:2048
    ds_read_b64_tr_b16 a[50:51], v12 offset:2048
    ds_read_b64_tr_b16 a[54:55], v13 offset:2048
    s_add_u32 m0, s48, 12288
    s_add_u32 s47, s70, 0
    buffer_load_dwordx4 v6, s[56:59], s47 offen lds
    buffer_load_dwordx4 v7, s[56:59], s47 offen offset:1024 lds
    v_mfma_f32_16x16x32_bf16 v[104:107], a[248:251], a[8:11], v[104:107]
    v_mfma_f32_16x16x32_bf16 v[136:139], a[252:255], a[8:11], v[136:139]
    v_mfma_f32_16x16x32_bf16 v[56:59], a[240:243], a[12:15], v[56:59]
    v_mfma_f32_16x16x32_bf16 v[76:79], a[244:247], a[12:15], v[76:79]
    v_mfma_f32_16x16x32_bf16 v[108:111], a[248:251], a[12:15], v[108:111]
    v_mfma_f32_16x16x32_bf16 v[140:143], a[252:255], a[12:15], v[140:143]
    ds_read_b128 v[184:187], v20 offset:2048
    s_add_u32 m0, s48, 14336
    s_add_u32 s47, s70, 14336
    buffer_load_dwordx4 v6, s[56:59], s47 offen lds
    buffer_load_dwordx4 v7, s[56:59], s47 offen offset:1024 lds
    v_mfma_f32_16x16x32_bf16 v[60:63], a[240:243], a[16:19], v[60:63]
    ds_read_b128 v[188:191], v20 offset:2304
    s_waitcnt vmcnt(10)
    v_mfma_f32_16x16x32_bf16 v[80:83], a[244:247], a[16:19], v[80:83]
    ds_read_b128 v[212:215], v20 offset:2560
    ds_read_b64_tr_b16 v[160:161], v10 offset:4096
    v_mfma_f32_16x16x32_bf16 v[112:115], a[248:251], a[16:19], v[112:115]
    ds_read_b128 v[216:219], v20 offset:2816
    ds_read_b64_tr_b16 v[164:165], v11 offset:4096
    v_mfma_f32_16x16x32_bf16 v[144:147], a[252:255], a[16:19], v[144:147]
    ds_read_b128 v[220:223], v20 offset:3072
    ds_read_b64_tr_b16 v[168:169], v12 offset:4096
    s_waitcnt lgkmcnt(8)
    s_waitcnt lgkmcnt(0)
    v_mfma_f32_16x16x32_bf16 v[44:47], a[40:43], a[20:23], v[44:47]
    v_add_f32 v184, v184, v185
    ds_read_b64_tr_b16 v[172:173], v13 offset:4096
    v_mfma_f32_16x16x32_bf16 v[64:67], a[44:47], a[20:23], v[64:67]
    v_add_f32 v186, v186, v187
    s_add_u32 m0, s48, 16384
    s_add_u32 s47, s71, 0
    buffer_load_dwordx4 v6, s[56:59], s47 offen lds
    buffer_load_dwordx4 v7, s[56:59], s47 offen offset:1024 lds
    v_mfma_f32_16x16x32_bf16 v[96:99], a[48:51], a[20:23], v[96:99]
    v_add_f32 v184, v184, v186
    s_waitcnt vmcnt(10)
    v_mfma_f32_16x16x32_bf16 v[128:131], a[52:55], a[20:23], v[128:131]
    v_rcp_f32 v32, v184
    ds_read_b64_tr_b16 v[162:163], v10 offset:6144
    v_mfma_f32_16x16x32_bf16 v[48:51], a[40:43], a[24:27], v[48:51]
    v_add_f32 v188, v188, v189
    ds_read_b64_tr_b16 v[166:167], v11 offset:6144
    v_mfma_f32_16x16x32_bf16 v[68:71], a[44:47], a[24:27], v[68:71]
    v_add_f32 v190, v190, v191
    ds_read_b64_tr_b16 v[170:171], v12 offset:6144
    v_mfma_f32_16x16x32_bf16 v[100:103], a[48:51], a[24:27], v[100:103]
    v_add_f32 v188, v188, v190
    ds_read_b64_tr_b16 v[174:175], v13 offset:6144
    v_mfma_f32_16x16x32_bf16 v[132:135], a[52:55], a[24:27], v[132:135]
    v_rcp_f32 v34, v188
    s_add_u32 m0, s48, 0
    s_add_u32 s47, s71, 14336
    buffer_load_dwordx4 v6, s[56:59], s47 offen lds
    buffer_load_dwordx4 v7, s[56:59], s47 offen offset:1024 lds
    v_mfma_f32_16x16x32_bf16 v[52:55], a[40:43], a[28:31], v[52:55]
    v_add_f32 v212, v212, v213
    s_waitcnt vmcnt(10)
    v_mfma_f32_16x16x32_bf16 v[72:75], a[44:47], a[28:31], v[72:75]
    v_add_f32 v214, v214, v215
    ds_read_b64_tr_b16 v[176:177], v10 offset:8192
    v_mfma_f32_16x16x32_bf16 v[104:107], a[48:51], a[28:31], v[104:107]
    v_add_f32 v212, v212, v214
    ds_read_b64_tr_b16 v[192:193], v11 offset:8192
    v_mfma_f32_16x16x32_bf16 v[136:139], a[52:55], a[28:31], v[136:139]
    v_rcp_f32 v36, v212
    ds_read_b64_tr_b16 v[196:197], v12 offset:8192
    v_mfma_f32_16x16x32_bf16 v[56:59], a[40:43], a[32:35], v[56:59]
    v_add_f32 v216, v216, v217
    ds_read_b64_tr_b16 v[200:201], v13 offset:8192
    v_mfma_f32_16x16x32_bf16 v[76:79], a[44:47], a[32:35], v[76:79]
    v_add_f32 v218, v218, v219
    s_add_u32 m0, s48, 2048
    s_add_u32 s47, s72, 0
    buffer_load_dwordx4 v6, s[56:59], s47 offen lds
    buffer_load_dwordx4 v7, s[56:59], s47 offen offset:1024 lds
    v_mfma_f32_16x16x32_bf16 v[108:111], a[48:51], a[32:35], v[108:111]
    v_add_f32 v216, v216, v218
    s_waitcnt vmcnt(10)
    v_mfma_f32_16x16x32_bf16 v[140:143], a[52:55], a[32:35], v[140:143]
    v_rcp_f32 v38, v216
    ds_read_b64_tr_b16 v[178:179], v10 offset:10240
    v_mfma_f32_16x16x32_bf16 v[60:63], a[40:43], a[36:39], v[60:63]
    v_add_f32 v220, v220, v221
    ds_read_b64_tr_b16 v[194:195], v11 offset:10240
    v_mfma_f32_16x16x32_bf16 v[80:83], a[44:47], a[36:39], v[80:83]
    v_add_f32 v222, v222, v223
    ds_read_b64_tr_b16 v[198:199], v12 offset:10240
    v_mfma_f32_16x16x32_bf16 v[112:115], a[48:51], a[36:39], v[112:115]
    v_add_f32 v220, v220, v222
    ds_read_b64_tr_b16 v[202:203], v13 offset:10240
    v_mfma_f32_16x16x32_bf16 v[144:147], a[52:55], a[36:39], v[144:147]
    v_rcp_f32 v40, v220
    v_pk_mul_f32 v[44:45], v[44:45], v[32:33] op_sel_hi:[1,0]
    v_pk_mul_f32 v[46:47], v[46:47], v[32:33] op_sel_hi:[1,0]
    v_cvt_pk_bf16_f32 v148, v44, v45
    v_cvt_pk_bf16_f32 v149, v46, v47
    v_pk_mul_f32 v[64:65], v[64:65], v[32:33] op_sel_hi:[1,0]
    v_pk_mul_f32 v[66:67], v[66:67], v[32:33] op_sel_hi:[1,0]
    v_cvt_pk_bf16_f32 v150, v64, v65
    v_cvt_pk_bf16_f32 v151, v66, v67
    ds_write_b128 v4, v[148:151]
    s_waitcnt lgkmcnt(13)
    s_add_u32 m0, s48, 4096
    s_add_u32 s47, s72, 14336
    buffer_load_dwordx4 v6, s[56:59], s47 offen lds
    buffer_load_dwordx4 v7, s[56:59], s47 offen offset:1024 lds
    v_pk_mul_f32 v[96:97], v[96:97], v[32:33] op_sel_hi:[1,0]
    v_pk_mul_f32 v[98:99], v[98:99], v[32:33] op_sel_hi:[1,0]
    v_cvt_pk_bf16_f32 v152, v96, v97
    v_cvt_pk_bf16_f32 v153, v98, v99
    v_pk_mul_f32 v[128:129], v[128:129], v[32:33] op_sel_hi:[1,0]
    v_pk_mul_f32 v[130:131], v[130:131], v[32:33] op_sel_hi:[1,0]
    v_cvt_pk_bf16_f32 v154, v128, v129
    v_cvt_pk_bf16_f32 v155, v130, v131
    ds_write_b128 v5, v[152:155]
    s_waitcnt vmcnt(10)
    v_pk_mul_f32 v[48:49], v[48:49], v[34:35] op_sel_hi:[1,0]
    v_pk_mul_f32 v[50:51], v[50:51], v[34:35] op_sel_hi:[1,0]
    v_cvt_pk_bf16_f32 v156, v48, v49
    v_cvt_pk_bf16_f32 v157, v50, v51
    v_pk_mul_f32 v[68:69], v[68:69], v[34:35] op_sel_hi:[1,0]
    v_pk_mul_f32 v[70:71], v[70:71], v[34:35] op_sel_hi:[1,0]
    v_cvt_pk_bf16_f32 v158, v68, v69
    v_cvt_pk_bf16_f32 v159, v70, v71
    ds_write_b128 v4, v[156:159] offset:1024
    ds_read_b64_tr_b16 v[204:205], v10 offset:12288
    v_pk_mul_f32 v[100:101], v[100:101], v[34:35] op_sel_hi:[1,0]
    v_pk_mul_f32 v[102:103], v[102:103], v[34:35] op_sel_hi:[1,0]
    v_cvt_pk_bf16_f32 v180, v100, v101
    v_cvt_pk_bf16_f32 v181, v102, v103
    v_pk_mul_f32 v[132:133], v[132:133], v[34:35] op_sel_hi:[1,0]
    v_pk_mul_f32 v[134:135], v[134:135], v[34:35] op_sel_hi:[1,0]
    v_cvt_pk_bf16_f32 v182, v132, v133
    v_cvt_pk_bf16_f32 v183, v134, v135
    ds_write_b128 v5, v[180:183] offset:1024
    ds_read_b64_tr_b16 v[208:209], v11 offset:12288
    v_pk_mul_f32 v[52:53], v[52:53], v[36:37] op_sel_hi:[1,0]
    v_pk_mul_f32 v[54:55], v[54:55], v[36:37] op_sel_hi:[1,0]
    v_cvt_pk_bf16_f32 v244, v52, v53
    v_cvt_pk_bf16_f32 v245, v54, v55
    v_pk_mul_f32 v[72:73], v[72:73], v[36:37] op_sel_hi:[1,0]
    v_pk_mul_f32 v[74:75], v[74:75], v[36:37] op_sel_hi:[1,0]
    v_cvt_pk_bf16_f32 v246, v72, v73
    v_cvt_pk_bf16_f32 v247, v74, v75
    ds_write_b128 v4, v[244:247] offset:2048
    ds_read_b64_tr_b16 v[224:225], v12 offset:12288
    v_pk_mul_f32 v[104:105], v[104:105], v[36:37] op_sel_hi:[1,0]
    v_pk_mul_f32 v[106:107], v[106:107], v[36:37] op_sel_hi:[1,0]
    v_cvt_pk_bf16_f32 v248, v104, v105
    v_cvt_pk_bf16_f32 v249, v106, v107
    v_pk_mul_f32 v[136:137], v[136:137], v[36:37] op_sel_hi:[1,0]
    v_pk_mul_f32 v[138:139], v[138:139], v[36:37] op_sel_hi:[1,0]
    v_cvt_pk_bf16_f32 v250, v136, v137
    v_cvt_pk_bf16_f32 v251, v138, v139
    ds_write_b128 v5, v[248:251] offset:2048
    ds_read_b64_tr_b16 v[228:229], v13 offset:12288
    v_pk_mul_f32 v[56:57], v[56:57], v[38:39] op_sel_hi:[1,0]
    v_pk_mul_f32 v[58:59], v[58:59], v[38:39] op_sel_hi:[1,0]
    v_cvt_pk_bf16_f32 v252, v56, v57
    v_cvt_pk_bf16_f32 v253, v58, v59
    v_pk_mul_f32 v[76:77], v[76:77], v[38:39] op_sel_hi:[1,0]
    v_pk_mul_f32 v[78:79], v[78:79], v[38:39] op_sel_hi:[1,0]
    v_cvt_pk_bf16_f32 v254, v76, v77
    v_cvt_pk_bf16_f32 v255, v78, v79
    ds_write_b128 v4, v[252:255] offset:3072
    s_waitcnt lgkmcnt(15)
    s_add_u32 m0, s48, 6144
    s_add_u32 s47, s73, 0
    buffer_load_dwordx4 v6, s[56:59], s47 offen lds
    buffer_load_dwordx4 v7, s[56:59], s47 offen offset:1024 lds
    v_pk_mul_f32 v[108:109], v[108:109], v[38:39] op_sel_hi:[1,0]
    v_pk_mul_f32 v[110:111], v[110:111], v[38:39] op_sel_hi:[1,0]
    v_cvt_pk_bf16_f32 v124, v108, v109
    v_cvt_pk_bf16_f32 v125, v110, v111
    v_pk_mul_f32 v[140:141], v[140:141], v[38:39] op_sel_hi:[1,0]
    v_pk_mul_f32 v[142:143], v[142:143], v[38:39] op_sel_hi:[1,0]
    v_cvt_pk_bf16_f32 v126, v140, v141
    v_cvt_pk_bf16_f32 v127, v142, v143
    ds_write_b128 v5, v[124:127] offset:3072
    s_add_u32 m0, s48, 8192
    s_add_u32 s47, s73, 14336
    buffer_load_dwordx4 v6, s[56:59], s47 offen lds
    buffer_load_dwordx4 v7, s[56:59], s47 offen offset:1024 lds
    v_pk_mul_f32 v[60:61], v[60:61], v[40:41] op_sel_hi:[1,0]
    v_pk_mul_f32 v[62:63], v[62:63], v[40:41] op_sel_hi:[1,0]
    v_cvt_pk_bf16_f32 v88, v60, v61
    v_cvt_pk_bf16_f32 v89, v62, v63
    v_pk_mul_f32 v[80:81], v[80:81], v[40:41] op_sel_hi:[1,0]
    v_pk_mul_f32 v[82:83], v[82:83], v[40:41] op_sel_hi:[1,0]
    v_cvt_pk_bf16_f32 v90, v80, v81
    v_cvt_pk_bf16_f32 v91, v82, v83
    ds_write_b128 v4, v[88:91] offset:4096
    s_waitcnt lgkmcnt(13)
    s_add_u32 m0, s48, 10240
    s_add_u32 s47, s74, 0
    buffer_load_dwordx4 v6, s[56:59], s47 offen lds
    buffer_load_dwordx4 v7, s[56:59], s47 offen offset:1024 lds
    v_pk_mul_f32 v[112:113], v[112:113], v[40:41] op_sel_hi:[1,0]
    v_pk_mul_f32 v[114:115], v[114:115], v[40:41] op_sel_hi:[1,0]
    v_cvt_pk_bf16_f32 v92, v112, v113
    v_cvt_pk_bf16_f32 v93, v114, v115
    v_pk_mul_f32 v[144:145], v[144:145], v[40:41] op_sel_hi:[1,0]
    v_pk_mul_f32 v[146:147], v[146:147], v[40:41] op_sel_hi:[1,0]
    v_cvt_pk_bf16_f32 v94, v144, v145
    v_cvt_pk_bf16_f32 v95, v146, v147
    ds_write_b128 v5, v[92:95] offset:4096
    s_waitcnt vmcnt(14)
    s_waitcnt lgkmcnt(0)
    s_barrier
    ds_read_b128 a[0:3], v16
    ds_read_b128 a[4:7], v16 offset:1024
    ds_read_b128 a[8:11], v16 offset:2048
    ds_read_b128 a[12:15], v16 offset:3072
    ds_read_b128 a[16:19], v16 offset:4096
    s_waitcnt lgkmcnt(4)
    v_mfma_f32_16x16x32_bf16 a[184:187], v[160:163], a[0:3], 0
    ds_read_b64_tr_b16 v[206:207], v10 offset:14336
    ds_read_b64_tr_b16 v[210:211], v11 offset:14336
    v_mfma_f32_16x16x32_bf16 a[204:207], v[164:167], a[0:3], 0
    ds_read_b128 a[20:23], v16 offset:5120
    ds_read_b64_tr_b16 v[226:227], v12 offset:14336
    v_mfma_f32_16x16x32_bf16 a[224:227], v[168:171], a[0:3], 0
    ds_read_b64_tr_b16 v[230:231], v13 offset:14336
    s_add_u32 m0, s48, 12288
    s_add_u32 s47, s74, 14336
    buffer_load_dwordx4 v6, s[56:59], s47 offen lds
    buffer_load_dwordx4 v7, s[56:59], s47 offen offset:1024 lds
    v_mfma_f32_16x16x32_bf16 a[244:247], v[172:175], a[0:3], 0
    ds_read_b128 a[24:27], v16 offset:6144
    s_waitcnt vmcnt(14)
    s_waitcnt lgkmcnt(9)
    v_mfma_f32_16x16x32_bf16 a[188:191], v[160:163], a[4:7], 0
    ds_read_b64_tr_b16 v[232:233], v10 offset:16384
    ds_read_b64_tr_b16 v[236:237], v11 offset:16384
    v_mfma_f32_16x16x32_bf16 a[208:211], v[164:167], a[4:7], 0
    ds_read_b128 a[28:31], v16 offset:7168
    ds_read_b64_tr_b16 v[240:241], v12 offset:16384
    v_mfma_f32_16x16x32_bf16 a[228:231], v[168:171], a[4:7], 0
    ds_read_b64_tr_b16 v[84:85], v13 offset:16384
    s_waitcnt vmcnt(12)
    v_mfma_f32_16x16x32_bf16 a[248:251], v[172:175], a[4:7], 0
    ds_read_b128 a[32:35], v16 offset:8192
    ds_read_b64_tr_b16 v[234:235], v10
    s_waitcnt lgkmcnt(15)
    v_mfma_f32_16x16x32_bf16 a[192:195], v[160:163], a[8:11], 0
    ds_read_b64_tr_b16 v[238:239], v11
    ds_read_b64_tr_b16 v[242:243], v12
    v_mfma_f32_16x16x32_bf16 a[212:215], v[164:167], a[8:11], 0
    ds_read_b128 a[36:39], v16 offset:9216
    ds_read_b64_tr_b16 v[86:87], v13
    v_mfma_f32_16x16x32_bf16 a[232:235], v[168:171], a[8:11], 0
    s_waitcnt lgkmcnt(12)
    s_add_u32 m0, s48, 14336
    s_add_u32 s47, s75, 0
    buffer_load_dwordx4 v6, s[56:59], s47 offen lds
    buffer_load_dwordx4 v7, s[56:59], s47 offen offset:1024 lds
    v_mfma_f32_16x16x32_bf16 a[252:255], v[172:175], a[8:11], 0
    s_waitcnt vmcnt(12)
    ds_read_b64_tr_b16 a[56:57], v10 offset:2048
    v_mfma_f32_16x16x32_bf16 a[196:199], v[160:163], a[12:15], 0
    ds_read_b64_tr_b16 a[60:61], v11 offset:2048
    ds_read_b64_tr_b16 a[64:65], v12 offset:2048
    v_mfma_f32_16x16x32_bf16 a[216:219], v[164:167], a[12:15], 0
    ds_read_b64_tr_b16 a[68:69], v13 offset:2048
    s_waitcnt vmcnt(10)
    v_mfma_f32_16x16x32_bf16 a[236:239], v[168:171], a[12:15], 0
    ds_read_b64_tr_b16 a[58:59], v10 offset:4096
    ds_read_b64_tr_b16 a[62:63], v11 offset:4096
    v_mfma_f32_16x16x32_bf16 a[40:43], v[172:175], a[12:15], 0
    ds_read_b64_tr_b16 a[66:67], v12 offset:4096
    ds_read_b64_tr_b16 a[70:71], v13 offset:4096
    v_mfma_f32_16x16x32_bf16 a[200:203], v[160:163], a[16:19], 0
    v_mfma_f32_16x16x32_bf16 a[220:223], v[164:167], a[16:19], 0
    v_mfma_f32_16x16x32_bf16 a[240:243], v[168:171], a[16:19], 0
    v_mfma_f32_16x16x32_bf16 a[44:47], v[172:175], a[16:19], 0
    s_waitcnt lgkmcnt(9)
    v_mfma_f32_16x16x32_bf16 a[184:187], v[176:179], a[20:23], a[184:187]
    v_mfma_f32_16x16x32_bf16 a[204:207], v[192:195], a[20:23], a[204:207]
    ds_read_b128 a[0:3], v16 offset:10240
    s_add_u32 m0, s48, 16384
    s_add_u32 s47, s75, 14336
    buffer_load_dwordx4 v6, s[56:59], s47 offen lds
    buffer_load_dwordx4 v7, s[56:59], s47 offen offset:1024 lds
    v_mfma_f32_16x16x32_bf16 a[224:227], v[196:199], a[20:23], a[224:227]
    s_waitcnt vmcnt(10)
    ds_read_b64_tr_b16 a[72:73], v10 offset:6144
    v_mfma_f32_16x16x32_bf16 a[244:247], v[200:203], a[20:23], a[244:247]
    ds_read_b128 a[4:7], v16 offset:11264
    ds_read_b64_tr_b16 a[76:77], v11 offset:6144
    v_mfma_f32_16x16x32_bf16 a[188:191], v[176:179], a[24:27], a[188:191]
    ds_read_b64_tr_b16 a[80:81], v12 offset:6144
    ds_read_b64_tr_b16 a[84:85], v13 offset:6144
    v_mfma_f32_16x16x32_bf16 a[208:211], v[192:195], a[24:27], a[208:211]
    ds_read_b128 a[8:11], v16 offset:12288
    v_mfma_f32_16x16x32_bf16 a[228:231], v[196:199], a[24:27], a[228:231]
    v_mfma_f32_16x16x32_bf16 a[248:251], v[200:203], a[24:27], a[248:251]
    ds_read_b128 a[12:15], v16 offset:13312
    s_waitcnt lgkmcnt(15)
    s_add_u32 m0, s48, 0
    s_add_u32 s47, s68, 0
    buffer_load_dwordx4 v6, s[64:67], s47 offen lds
    buffer_load_dwordx4 v7, s[64:67], s47 offen offset:1024 lds
    v_mfma_f32_16x16x32_bf16 a[192:195], v[176:179], a[28:31], a[192:195]
    s_waitcnt vmcnt(10)
    ds_read_b64_tr_b16 a[74:75], v10 offset:8192
    v_mfma_f32_16x16x32_bf16 a[212:215], v[192:195], a[28:31], a[212:215]
    ds_read_b128 a[16:19], v16 offset:14336
    ds_read_b64_tr_b16 a[78:79], v11 offset:8192
    v_mfma_f32_16x16x32_bf16 a[232:235], v[196:199], a[28:31], a[232:235]
    ds_read_b64_tr_b16 a[82:83], v12 offset:8192
    ds_read_b64_tr_b16 a[86:87], v13 offset:8192
    v_mfma_f32_16x16x32_bf16 a[252:255], v[200:203], a[28:31], a[252:255]
    v_mfma_f32_16x16x32_bf16 a[196:199], v[176:179], a[32:35], a[196:199]
    v_mfma_f32_16x16x32_bf16 a[216:219], v[192:195], a[32:35], a[216:219]
    s_waitcnt lgkmcnt(15)
    s_add_u32 m0, s48, 2048
    s_add_u32 s47, s68, 14336
    buffer_load_dwordx4 v6, s[64:67], s47 offen lds
    buffer_load_dwordx4 v7, s[64:67], s47 offen offset:1024 lds
    v_mfma_f32_16x16x32_bf16 a[236:239], v[196:199], a[32:35], a[236:239]
    s_waitcnt vmcnt(10)
    ds_read_b64_tr_b16 a[88:89], v10 offset:10240
    v_mfma_f32_16x16x32_bf16 a[40:43], v[200:203], a[32:35], a[40:43]
    ds_read_b64_tr_b16 a[92:93], v11 offset:10240
    ds_read_b64_tr_b16 a[96:97], v12 offset:10240
    v_mfma_f32_16x16x32_bf16 a[200:203], v[176:179], a[36:39], a[200:203]
    ds_read_b64_tr_b16 a[100:101], v13 offset:10240
    v_mfma_f32_16x16x32_bf16 a[220:223], v[192:195], a[36:39], a[220:223]
    v_mfma_f32_16x16x32_bf16 a[240:243], v[196:199], a[36:39], a[240:243]
    v_mfma_f32_16x16x32_bf16 a[44:47], v[200:203], a[36:39], a[44:47]
    s_waitcnt lgkmcnt(15)
    s_add_u32 m0, s48, 4096
    s_add_u32 s47, s69, 0
    buffer_load_dwordx4 v6, s[64:67], s47 offen lds
    buffer_load_dwordx4 v7, s[64:67], s47 offen offset:1024 lds
    s_waitcnt lgkmcnt(7)
    v_mfma_f32_16x16x32_bf16 a[184:187], v[204:207], a[0:3], a[184:187]
    s_waitcnt vmcnt(10)
    ds_read_b64_tr_b16 a[90:91], v10 offset:12288
    v_mfma_f32_16x16x32_bf16 a[204:207], v[208:211], a[0:3], a[204:207]
    ds_read_b128 a[20:23], v16 offset:15360
    ds_read_b64_tr_b16 a[94:95], v11 offset:12288
    v_mfma_f32_16x16x32_bf16 a[224:227], v[224:227], a[0:3], a[224:227]
    ds_read_b64_tr_b16 a[98:99], v12 offset:12288
    ds_read_b64_tr_b16 a[102:103], v13 offset:12288
    v_mfma_f32_16x16x32_bf16 a[244:247], v[228:231], a[0:3], a[244:247]
    ds_read_b128 a[24:27], v16 offset:16384
    v_mfma_f32_16x16x32_bf16 a[188:191], v[204:207], a[4:7], a[188:191]
    v_mfma_f32_16x16x32_bf16 a[208:211], v[208:211], a[4:7], a[208:211]
    ds_read_b128 a[28:31], v16 offset:17408
    s_add_u32 m0, s48, 6144
    s_add_u32 s47, s69, 14336
    buffer_load_dwordx4 v6, s[64:67], s47 offen lds
    buffer_load_dwordx4 v7, s[64:67], s47 offen offset:1024 lds
    v_mfma_f32_16x16x32_bf16 a[228:231], v[224:227], a[4:7], a[228:231]
    s_waitcnt vmcnt(10)
    ds_read_b64_tr_b16 a[104:105], v10 offset:14336
    v_mfma_f32_16x16x32_bf16 a[248:251], v[228:231], a[4:7], a[248:251]
    ds_read_b128 a[32:35], v16 offset:18432
    ds_read_b64_tr_b16 a[108:109], v11 offset:14336
    v_mfma_f32_16x16x32_bf16 a[192:195], v[204:207], a[8:11], a[192:195]
    ds_read_b64_tr_b16 a[112:113], v12 offset:14336
    ds_read_b64_tr_b16 a[116:117], v13 offset:14336
    v_mfma_f32_16x16x32_bf16 a[212:215], v[208:211], a[8:11], a[212:215]
    ds_read_b128 a[36:39], v16 offset:19456
    v_mfma_f32_16x16x32_bf16 a[232:235], v[224:227], a[8:11], a[232:235]
    v_mfma_f32_16x16x32_bf16 a[252:255], v[228:231], a[8:11], a[252:255]
    v_mfma_f32_16x16x32_bf16 a[196:199], v[204:207], a[12:15], a[196:199]
    v_mfma_f32_16x16x32_bf16 a[216:219], v[208:211], a[12:15], a[216:219]
    s_waitcnt lgkmcnt(15)
    s_add_u32 m0, s48, 8192
    s_add_u32 s47, s70, 0
    buffer_load_dwordx4 v6, s[64:67], s47 offen lds
    buffer_load_dwordx4 v7, s[64:67], s47 offen offset:1024 lds
    v_mfma_f32_16x16x32_bf16 a[236:239], v[224:227], a[12:15], a[236:239]
    s_waitcnt vmcnt(10)
    ds_read_b64_tr_b16 a[106:107], v10 offset:16384
    v_mfma_f32_16x16x32_bf16 a[40:43], v[228:231], a[12:15], a[40:43]
    ds_read_b64_tr_b16 a[110:111], v11 offset:16384
    ds_read_b64_tr_b16 a[114:115], v12 offset:16384
    v_mfma_f32_16x16x32_bf16 a[200:203], v[204:207], a[16:19], a[200:203]
    ds_read_b64_tr_b16 a[118:119], v13 offset:16384
    v_mfma_f32_16x16x32_bf16 a[220:223], v[208:211], a[16:19], a[220:223]
    v_mfma_f32_16x16x32_bf16 a[240:243], v[224:227], a[16:19], a[240:243]
    v_mfma_f32_16x16x32_bf16 a[44:47], v[228:231], a[16:19], a[44:47]
    s_waitcnt lgkmcnt(15)
    s_add_u32 m0, s48, 10240
    s_add_u32 s47, s70, 14336
    buffer_load_dwordx4 v6, s[64:67], s47 offen lds
    buffer_load_dwordx4 v7, s[64:67], s47 offen offset:1024 lds
    s_waitcnt lgkmcnt(4)
    v_mfma_f32_16x16x32_bf16 a[184:187], v[232:235], a[20:23], a[184:187]
    s_waitcnt vmcnt(10)
    ds_read_b64_tr_b16 a[120:121], v10
    v_mfma_f32_16x16x32_bf16 a[204:207], v[236:239], a[20:23], a[204:207]
    ds_read_b128 a[0:3], v16 offset:20480
    ds_read_b64_tr_b16 a[124:125], v11
    v_mfma_f32_16x16x32_bf16 a[224:227], v[240:243], a[20:23], a[224:227]
    ds_read_b64_tr_b16 a[128:129], v12
    ds_read_b64_tr_b16 a[132:133], v13
    v_mfma_f32_16x16x32_bf16 a[244:247], v[84:87], a[20:23], a[244:247]
    ds_read_b128 a[4:7], v16 offset:21504
    v_mfma_f32_16x16x32_bf16 a[188:191], v[232:235], a[24:27], a[188:191]
    v_mfma_f32_16x16x32_bf16 a[208:211], v[236:239], a[24:27], a[208:211]
    ds_read_b128 a[8:11], v16 offset:22528
    s_add_u32 m0, s48, 12288
    s_add_u32 s47, s71, 0
    buffer_load_dwordx4 v6, s[64:67], s47 offen lds
    buffer_load_dwordx4 v7, s[64:67], s47 offen offset:1024 lds
    v_mfma_f32_16x16x32_bf16 a[228:231], v[240:243], a[24:27], a[228:231]
    s_waitcnt vmcnt(10)
    ds_read_b64_tr_b16 a[122:123], v10 offset:2048
    v_mfma_f32_16x16x32_bf16 a[248:251], v[84:87], a[24:27], a[248:251]
    ds_read_b128 a[12:15], v16 offset:23552
    ds_read_b64_tr_b16 a[126:127], v11 offset:2048
    v_mfma_f32_16x16x32_bf16 a[192:195], v[232:235], a[28:31], a[192:195]
    ds_read_b64_tr_b16 a[130:131], v12 offset:2048
    ds_read_b64_tr_b16 a[134:135], v13 offset:2048
    v_mfma_f32_16x16x32_bf16 a[212:215], v[236:239], a[28:31], a[212:215]
    ds_read_b128 a[16:19], v16 offset:24576
    v_mfma_f32_16x16x32_bf16 a[232:235], v[240:243], a[28:31], a[232:235]
    v_mfma_f32_16x16x32_bf16 a[252:255], v[84:87], a[28:31], a[252:255]
    s_add_u32 m0, s48, 14336
    s_add_u32 s47, s71, 14336
    buffer_load_dwordx4 v6, s[64:67], s47 offen lds
    buffer_load_dwordx4 v7, s[64:67], s47 offen offset:1024 lds
    v_mfma_f32_16x16x32_bf16 a[196:199], v[232:235], a[32:35], a[196:199]
    s_waitcnt vmcnt(10)
    ds_read_b64_tr_b16 a[136:137], v10 offset:4096
    v_mfma_f32_16x16x32_bf16 a[216:219], v[236:239], a[32:35], a[216:219]
    ds_read_b64_tr_b16 a[140:141], v11 offset:4096
    ds_read_b64_tr_b16 a[144:145], v12 offset:4096
    v_mfma_f32_16x16x32_bf16 a[236:239], v[240:243], a[32:35], a[236:239]
    ds_read_b64_tr_b16 a[148:149], v13 offset:4096
    v_mfma_f32_16x16x32_bf16 a[40:43], v[84:87], a[32:35], a[40:43]
    v_mfma_f32_16x16x32_bf16 a[200:203], v[232:235], a[36:39], a[200:203]
    v_mfma_f32_16x16x32_bf16 a[220:223], v[236:239], a[36:39], a[220:223]
    v_mfma_f32_16x16x32_bf16 a[240:243], v[240:243], a[36:39], a[240:243]
    s_waitcnt lgkmcnt(15)
    s_add_u32 m0, s48, 16384
    s_add_u32 s47, s72, 0
    buffer_load_dwordx4 v6, s[64:67], s47 offen lds
    buffer_load_dwordx4 v7, s[64:67], s47 offen offset:1024 lds
    v_mfma_f32_16x16x32_bf16 a[44:47], v[84:87], a[36:39], a[44:47]
    s_waitcnt vmcnt(10)
    ds_read_b64_tr_b16 a[138:139], v10 offset:6144
    s_waitcnt lgkmcnt(5)
    v_mfma_f32_16x16x32_bf16 a[184:187], a[56:59], a[0:3], a[184:187]
    ds_read_b64_tr_b16 a[142:143], v11 offset:6144
    ds_read_b64_tr_b16 a[146:147], v12 offset:6144
    v_mfma_f32_16x16x32_bf16 a[204:207], a[60:63], a[0:3], a[204:207]
    ds_read_b128 a[20:23], v16 offset:25600
    ds_read_b64_tr_b16 a[150:151], v13 offset:6144
    v_mfma_f32_16x16x32_bf16 a[224:227], a[64:67], a[0:3], a[224:227]
    v_mfma_f32_16x16x32_bf16 a[244:247], a[68:71], a[0:3], a[244:247]
    ds_read_b128 a[24:27], v16 offset:26624
    v_mfma_f32_16x16x32_bf16 a[188:191], a[56:59], a[4:7], a[188:191]
    v_mfma_f32_16x16x32_bf16 a[208:211], a[60:63], a[4:7], a[208:211]
    ds_read_b128 a[28:31], v16 offset:27648
    s_add_u32 m0, s48, 0
    s_add_u32 s47, s72, 14336
    buffer_load_dwordx4 v6, s[64:67], s47 offen lds
    buffer_load_dwordx4 v7, s[64:67], s47 offen offset:1024 lds
    v_mfma_f32_16x16x32_bf16 a[228:231], a[64:67], a[4:7], a[228:231]
    s_waitcnt vmcnt(10)
    ds_read_b64_tr_b16 a[152:153], v10 offset:8192
    v_mfma_f32_16x16x32_bf16 a[248:251], a[68:71], a[4:7], a[248:251]
    ds_read_b128 a[32:35], v16 offset:28672
    ds_read_b64_tr_b16 a[156:157], v11 offset:8192
    v_mfma_f32_16x16x32_bf16 a[192:195], a[56:59], a[8:11], a[192:195]
    ds_read_b64_tr_b16 a[160:161], v12 offset:8192
    ds_read_b64_tr_b16 a[164:165], v13 offset:8192
    v_mfma_f32_16x16x32_bf16 a[212:215], a[60:63], a[8:11], a[212:215]
    ds_read_b128 a[36:39], v16 offset:29696
    v_mfma_f32_16x16x32_bf16 a[232:235], a[64:67], a[8:11], a[232:235]
    v_mfma_f32_16x16x32_bf16 a[252:255], a[68:71], a[8:11], a[252:255]
    s_add_u32 m0, s48, 2048
    s_add_u32 s47, s73, 0
    buffer_load_dwordx4 v6, s[64:67], s47 offen lds
    buffer_load_dwordx4 v7, s[64:67], s47 offen offset:1024 lds
    v_mfma_f32_16x16x32_bf16 a[196:199], a[56:59], a[12:15], a[196:199]
    s_waitcnt vmcnt(10)
    ds_read_b64_tr_b16 a[154:155], v10 offset:10240
    v_mfma_f32_16x16x32_bf16 a[216:219], a[60:63], a[12:15], a[216:219]
    ds_read_b64_tr_b16 a[158:159], v11 offset:10240
    ds_read_b64_tr_b16 a[162:163], v12 offset:10240
    v_mfma_f32_16x16x32_bf16 a[236:239], a[64:67], a[12:15], a[236:239]
    ds_read_b64_tr_b16 a[166:167], v13 offset:10240
    v_mfma_f32_16x16x32_bf16 a[40:43], a[68:71], a[12:15], a[40:43]
    v_mfma_f32_16x16x32_bf16 a[200:203], a[56:59], a[16:19], a[200:203]
    v_mfma_f32_16x16x32_bf16 a[220:223], a[60:63], a[16:19], a[220:223]
    v_mfma_f32_16x16x32_bf16 a[240:243], a[64:67], a[16:19], a[240:243]
    s_waitcnt lgkmcnt(15)
    s_add_u32 m0, s48, 4096
    s_add_u32 s47, s73, 14336
    buffer_load_dwordx4 v6, s[64:67], s47 offen lds
    buffer_load_dwordx4 v7, s[64:67], s47 offen offset:1024 lds
    v_mfma_f32_16x16x32_bf16 a[44:47], a[68:71], a[16:19], a[44:47]
    s_waitcnt vmcnt(10)
    ds_read_b64_tr_b16 a[168:169], v10 offset:12288
    s_waitcnt lgkmcnt(5)
    v_mfma_f32_16x16x32_bf16 a[184:187], a[72:75], a[20:23], a[184:187]
    ds_read_b64_tr_b16 a[172:173], v11 offset:12288
    ds_read_b64_tr_b16 a[176:177], v12 offset:12288
    v_mfma_f32_16x16x32_bf16 a[204:207], a[76:79], a[20:23], a[204:207]
    ds_read_b128 a[0:3], v16 offset:30720
    ds_read_b64_tr_b16 a[180:181], v13 offset:12288
    v_mfma_f32_16x16x32_bf16 a[224:227], a[80:83], a[20:23], a[224:227]
    v_mfma_f32_16x16x32_bf16 a[244:247], a[84:87], a[20:23], a[244:247]
    ds_read_b128 a[4:7], v16 offset:31744
    v_mfma_f32_16x16x32_bf16 a[188:191], a[72:75], a[24:27], a[188:191]
    s_add_u32 m0, s48, 6144
    s_add_u32 s47, s74, 0
    buffer_load_dwordx4 v6, s[64:67], s47 offen lds
    buffer_load_dwordx4 v7, s[64:67], s47 offen offset:1024 lds
    v_mfma_f32_16x16x32_bf16 a[208:211], a[76:79], a[24:27], a[208:211]
    ds_read_b128 a[8:11], v16 offset:32768
    s_waitcnt vmcnt(10)
    v_mfma_f32_16x16x32_bf16 a[228:231], a[80:83], a[24:27], a[228:231]
    ds_read_b64_tr_b16 a[170:171], v10 offset:14336
    ds_read_b64_tr_b16 a[174:175], v11 offset:14336
    v_mfma_f32_16x16x32_bf16 a[248:251], a[84:87], a[24:27], a[248:251]
    ds_read_b128 a[12:15], v16 offset:33792
    ds_read_b64_tr_b16 a[178:179], v12 offset:14336
    v_mfma_f32_16x16x32_bf16 a[192:195], a[72:75], a[28:31], a[192:195]
    ds_read_b64_tr_b16 a[182:183], v13 offset:14336
    v_mfma_f32_16x16x32_bf16 a[212:215], a[76:79], a[28:31], a[212:215]
    ds_read_b128 a[16:19], v16 offset:34816
    v_mfma_f32_16x16x32_bf16 a[232:235], a[80:83], a[28:31], a[232:235]
    s_add_u32 m0, s48, 8192
    s_add_u32 s47, s74, 14336
    buffer_load_dwordx4 v6, s[64:67], s47 offen lds
    buffer_load_dwordx4 v7, s[64:67], s47 offen offset:1024 lds
    v_mfma_f32_16x16x32_bf16 a[252:255], a[84:87], a[28:31], a[252:255]
    s_waitcnt vmcnt(10)
    ds_read_b64_tr_b16 v[160:161], v10 offset:16384
    v_mfma_f32_16x16x32_bf16 a[196:199], a[72:75], a[32:35], a[196:199]
    ds_read_b64_tr_b16 v[164:165], v11 offset:16384
    ds_read_b64_tr_b16 v[168:169], v12 offset:16384
    v_mfma_f32_16x16x32_bf16 a[216:219], a[76:79], a[32:35], a[216:219]
    ds_read_b64_tr_b16 v[172:173], v13 offset:16384
    v_mfma_f32_16x16x32_bf16 a[236:239], a[80:83], a[32:35], a[236:239]
    v_mfma_f32_16x16x32_bf16 a[40:43], a[84:87], a[32:35], a[40:43]
    v_mfma_f32_16x16x32_bf16 a[200:203], a[72:75], a[36:39], a[200:203]
    v_mfma_f32_16x16x32_bf16 a[220:223], a[76:79], a[36:39], a[220:223]
    v_mfma_f32_16x16x32_bf16 a[240:243], a[80:83], a[36:39], a[240:243]
    s_waitcnt lgkmcnt(15)
    s_add_u32 m0, s48, 10240
    s_add_u32 s47, s75, 0
    buffer_load_dwordx4 v6, s[64:67], s47 offen lds
    buffer_load_dwordx4 v7, s[64:67], s47 offen offset:1024 lds
    v_mfma_f32_16x16x32_bf16 a[44:47], a[84:87], a[36:39], a[44:47]
    s_waitcnt vmcnt(10)
    ds_read_b64_tr_b16 v[162:163], v10
    s_waitcnt lgkmcnt(5)
    v_mfma_f32_16x16x32_bf16 a[184:187], a[88:91], a[0:3], a[184:187]
    ds_read_b64_tr_b16 v[166:167], v11
    ds_read_b64_tr_b16 v[170:171], v12
    v_mfma_f32_16x16x32_bf16 a[204:207], a[92:95], a[0:3], a[204:207]
    ds_read_b128 a[20:23], v16 offset:35840
    ds_read_b64_tr_b16 v[174:175], v13
    v_mfma_f32_16x16x32_bf16 a[224:227], a[96:99], a[0:3], a[224:227]
    v_mfma_f32_16x16x32_bf16 a[244:247], a[100:103], a[0:3], a[244:247]
    ds_read_b128 a[24:27], v16 offset:36864
    v_mfma_f32_16x16x32_bf16 a[188:191], a[88:91], a[4:7], a[188:191]
    s_add_u32 m0, s48, 12288
    s_add_u32 s47, s75, 14336
    buffer_load_dwordx4 v6, s[64:67], s47 offen lds
    buffer_load_dwordx4 v7, s[64:67], s47 offen offset:1024 lds
    v_mfma_f32_16x16x32_bf16 a[208:211], a[92:95], a[4:7], a[208:211]
    ds_read_b128 a[28:31], v16 offset:37888
    s_waitcnt vmcnt(10)
    v_mfma_f32_16x16x32_bf16 a[228:231], a[96:99], a[4:7], a[228:231]
    ds_read_b64_tr_b16 v[176:177], v10 offset:2048
    ds_read_b64_tr_b16 v[192:193], v11 offset:2048
    v_mfma_f32_16x16x32_bf16 a[248:251], a[100:103], a[4:7], a[248:251]
    ds_read_b128 a[32:35], v16 offset:38912
    ds_read_b64_tr_b16 v[196:197], v12 offset:2048
    v_mfma_f32_16x16x32_bf16 a[192:195], a[88:91], a[8:11], a[192:195]
    ds_read_b64_tr_b16 v[200:201], v13 offset:2048
    v_mfma_f32_16x16x32_bf16 a[212:215], a[92:95], a[8:11], a[212:215]
    ds_read_b128 a[36:39], v16 offset:39936
    v_mfma_f32_16x16x32_bf16 a[232:235], a[96:99], a[8:11], a[232:235]
    v_mfma_f32_16x16x32_bf16 a[252:255], a[100:103], a[8:11], a[252:255]
    s_waitcnt vmcnt(8)
    ds_read_b64_tr_b16 v[178:179], v10 offset:4096
    v_mfma_f32_16x16x32_bf16 a[196:199], a[88:91], a[12:15], a[196:199]
    ds_read_b64_tr_b16 v[194:195], v11 offset:4096
    ds_read_b64_tr_b16 v[198:199], v12 offset:4096
    v_mfma_f32_16x16x32_bf16 a[216:219], a[92:95], a[12:15], a[216:219]
    ds_read_b64_tr_b16 v[202:203], v13 offset:4096
    v_mfma_f32_16x16x32_bf16 a[236:239], a[96:99], a[12:15], a[236:239]
    v_mfma_f32_16x16x32_bf16 a[40:43], a[100:103], a[12:15], a[40:43]
    v_mfma_f32_16x16x32_bf16 a[200:203], a[88:91], a[16:19], a[200:203]
    v_mfma_f32_16x16x32_bf16 a[220:223], a[92:95], a[16:19], a[220:223]
    v_mfma_f32_16x16x32_bf16 a[240:243], a[96:99], a[16:19], a[240:243]
    s_waitcnt vmcnt(6)
    ds_read_b64_tr_b16 v[204:205], v10 offset:6144
    v_mfma_f32_16x16x32_bf16 a[44:47], a[100:103], a[16:19], a[44:47]
    ds_read_b64_tr_b16 v[208:209], v11 offset:6144
    ds_read_b64_tr_b16 v[224:225], v12 offset:6144
    s_waitcnt lgkmcnt(7)
    v_mfma_f32_16x16x32_bf16 a[184:187], a[104:107], a[20:23], a[184:187]
    ds_read_b64_tr_b16 v[228:229], v13 offset:6144
    v_mfma_f32_16x16x32_bf16 a[204:207], a[108:111], a[20:23], a[204:207]
    ds_read_b128 a[0:3], v16
    v_mfma_f32_16x16x32_bf16 a[224:227], a[112:115], a[20:23], a[224:227]
    v_mfma_f32_16x16x32_bf16 a[244:247], a[116:119], a[20:23], a[244:247]
    ds_read_b128 a[4:7], v16 offset:1024
    v_mfma_f32_16x16x32_bf16 a[188:191], a[104:107], a[24:27], a[188:191]
    v_mfma_f32_16x16x32_bf16 a[208:211], a[108:111], a[24:27], a[208:211]
    ds_read_b128 a[8:11], v16 offset:2048
    s_waitcnt vmcnt(4)
    v_mfma_f32_16x16x32_bf16 a[228:231], a[112:115], a[24:27], a[228:231]
    ds_read_b64_tr_b16 v[206:207], v10 offset:8192
    ds_read_b64_tr_b16 v[210:211], v11 offset:8192
    v_mfma_f32_16x16x32_bf16 a[248:251], a[116:119], a[24:27], a[248:251]
    ds_read_b128 a[12:15], v16 offset:3072
    ds_read_b64_tr_b16 v[226:227], v12 offset:8192
    v_mfma_f32_16x16x32_bf16 a[192:195], a[104:107], a[28:31], a[192:195]
    ds_read_b64_tr_b16 v[230:231], v13 offset:8192
    v_mfma_f32_16x16x32_bf16 a[212:215], a[108:111], a[28:31], a[212:215]
    ds_read_b128 a[16:19], v16 offset:4096
    v_mfma_f32_16x16x32_bf16 a[232:235], a[112:115], a[28:31], a[232:235]
    v_mfma_f32_16x16x32_bf16 a[252:255], a[116:119], a[28:31], a[252:255]
    v_mfma_f32_16x16x32_bf16 a[196:199], a[104:107], a[32:35], a[196:199]
    v_mfma_f32_16x16x32_bf16 a[216:219], a[108:111], a[32:35], a[216:219]
    v_mfma_f32_16x16x32_bf16 a[236:239], a[112:115], a[32:35], a[236:239]
    s_waitcnt vmcnt(2)
    ds_read_b64_tr_b16 v[232:233], v10 offset:10240
    v_mfma_f32_16x16x32_bf16 a[40:43], a[116:119], a[32:35], a[40:43]
    ds_read_b64_tr_b16 v[236:237], v11 offset:10240
    ds_read_b64_tr_b16 v[240:241], v12 offset:10240
    v_mfma_f32_16x16x32_bf16 a[200:203], a[104:107], a[36:39], a[200:203]
    ds_read_b64_tr_b16 v[84:85], v13 offset:10240
    v_mfma_f32_16x16x32_bf16 a[220:223], a[108:111], a[36:39], a[220:223]
    v_mfma_f32_16x16x32_bf16 a[240:243], a[112:115], a[36:39], a[240:243]
    v_mfma_f32_16x16x32_bf16 a[44:47], a[116:119], a[36:39], a[44:47]
    s_cmp_eq_u32 s40, 3
    s_cbranch_scc1 L_w3_tail
    s_waitcnt lgkmcnt(4)
    v_mfma_f32_16x16x32_bf16 v[44:47], a[120:123], a[0:3], 0
    ds_read_b128 a[20:23], v16 offset:5120
    v_mfma_f32_16x16x32_bf16 v[64:67], a[124:127], a[0:3], 0
    ds_read_b128 a[24:27], v16 offset:6144
    ds_read_b128 a[28:31], v16 offset:7168
    s_waitcnt vmcnt(0)
    v_mfma_f32_16x16x32_bf16 v[96:99], a[128:131], a[0:3], 0
    ds_read_b128 a[32:35], v16 offset:8192
    ds_read_b128 a[36:39], v16 offset:9216
    ds_read_b64_tr_b16 v[234:235], v10 offset:12288
    v_mfma_f32_16x16x32_bf16 v[128:131], a[132:135], a[0:3], 0
    ds_read_b64_tr_b16 v[238:239], v11 offset:12288
    ds_read_b64_tr_b16 v[242:243], v12 offset:12288
    v_mfma_f32_16x16x32_bf16 v[48:51], a[120:123], a[4:7], 0
    ds_read_b64_tr_b16 v[86:87], v13 offset:12288
    v_mfma_f32_16x16x32_bf16 v[68:71], a[124:127], a[4:7], 0
    v_mfma_f32_16x16x32_bf16 v[100:103], a[128:131], a[4:7], 0
    v_mfma_f32_16x16x32_bf16 v[132:135], a[132:135], a[4:7], 0
    v_accvgpr_read_b32 v212, a184
    v_accvgpr_read_b32 v213, a185
    v_mfma_f32_16x16x32_bf16 v[52:55], a[120:123], a[8:11], 0
    v_accvgpr_read_b32 v214, a186
    v_accvgpr_read_b32 v215, a187
    v_mfma_f32_16x16x32_bf16 v[72:75], a[124:127], a[8:11], 0
    v_cvt_pk_bf16_f32 v148, v212, v213
    v_cvt_pk_bf16_f32 v149, v214, v215
    v_mfma_f32_16x16x32_bf16 v[104:107], a[128:131], a[8:11], 0
    v_accvgpr_read_b32 v216, a204
    v_mfma_f32_16x16x32_bf16 v[136:139], a[132:135], a[8:11], 0
    v_accvgpr_read_b32 v217, a205
    v_accvgpr_read_b32 v218, a206
    v_mfma_f32_16x16x32_bf16 v[56:59], a[120:123], a[12:15], 0
    v_accvgpr_read_b32 v219, a207
    v_cvt_pk_bf16_f32 v150, v216, v217
    v_mfma_f32_16x16x32_bf16 v[76:79], a[124:127], a[12:15], 0
    v_cvt_pk_bf16_f32 v151, v218, v219
    v_mfma_f32_16x16x32_bf16 v[108:111], a[128:131], a[12:15], 0
    s_mov_b32 s47, 0
    buffer_store_dwordx4 v[148:151], v16, s[36:39], s47 offen sc1
    v_accvgpr_read_b32 v220, a224
    v_mfma_f32_16x16x32_bf16 v[140:143], a[132:135], a[12:15], 0
    v_accvgpr_read_b32 v221, a225
    v_accvgpr_read_b32 v222, a226
    v_mfma_f32_16x16x32_bf16 v[60:63], a[120:123], a[16:19], 0
    v_accvgpr_read_b32 v223, a227
    v_mfma_f32_16x16x32_bf16 v[80:83], a[124:127], a[16:19], 0
    v_cvt_pk_bf16_f32 v152, v220, v221
    v_mfma_f32_16x16x32_bf16 v[112:115], a[128:131], a[16:19], 0
    v_mfma_f32_16x16x32_bf16 v[144:147], a[132:135], a[16:19], 0
    s_waitcnt lgkmcnt(4)
    v_mfma_f32_16x16x32_bf16 v[44:47], a[136:139], a[20:23], v[44:47]
    ds_read_b128 a[0:3], v16 offset:10240
    v_mfma_f32_16x16x32_bf16 v[64:67], a[140:143], a[20:23], v[64:67]
    ds_read_b128 a[4:7], v16 offset:11264
    v_mfma_f32_16x16x32_bf16 v[96:99], a[144:147], a[20:23], v[96:99]
    ds_read_b128 a[8:11], v16 offset:12288
    ds_read_b128 a[12:15], v16 offset:13312
    v_mfma_f32_16x16x32_bf16 v[128:131], a[148:151], a[20:23], v[128:131]
    ds_read_b128 a[16:19], v16 offset:14336
    v_mfma_f32_16x16x32_bf16 v[48:51], a[136:139], a[24:27], v[48:51]
    v_cvt_pk_bf16_f32 v153, v222, v223
    v_accvgpr_read_b32 v184, a244
    v_mfma_f32_16x16x32_bf16 v[68:71], a[140:143], a[24:27], v[68:71]
    v_accvgpr_read_b32 v185, a245
    v_mfma_f32_16x16x32_bf16 v[100:103], a[144:147], a[24:27], v[100:103]
    v_accvgpr_read_b32 v186, a246
    v_accvgpr_read_b32 v187, a247
    v_mfma_f32_16x16x32_bf16 v[132:135], a[148:151], a[24:27], v[132:135]
    v_cvt_pk_bf16_f32 v154, v184, v185
    v_mfma_f32_16x16x32_bf16 v[52:55], a[136:139], a[28:31], v[52:55]
    v_cvt_pk_bf16_f32 v155, v186, v187
    s_mov_b32 s47, 81920
    buffer_store_dwordx4 v[152:155], v16, s[36:39], s47 offen sc1
    v_mfma_f32_16x16x32_bf16 v[72:75], a[140:143], a[28:31], v[72:75]
    v_accvgpr_read_b32 v188, a188
    v_mfma_f32_16x16x32_bf16 v[104:107], a[144:147], a[28:31], v[104:107]
    v_accvgpr_read_b32 v189, a189
    v_mfma_f32_16x16x32_bf16 v[136:139], a[148:151], a[28:31], v[136:139]
    v_accvgpr_read_b32 v190, a190
    v_accvgpr_read_b32 v191, a191
    v_mfma_f32_16x16x32_bf16 v[56:59], a[136:139], a[32:35], v[56:59]
    v_cvt_pk_bf16_f32 v156, v188, v189
    v_mfma_f32_16x16x32_bf16 v[76:79], a[140:143], a[32:35], v[76:79]
    v_cvt_pk_bf16_f32 v157, v190, v191
    v_accvgpr_read_b32 v212, a208
    v_mfma_f32_16x16x32_bf16 v[108:111], a[144:147], a[32:35], v[108:111]
    v_accvgpr_read_b32 v213, a209
    v_mfma_f32_16x16x32_bf16 v[140:143], a[148:151], a[32:35], v[140:143]
    v_accvgpr_read_b32 v214, a210
    v_accvgpr_read_b32 v215, a211
    v_mfma_f32_16x16x32_bf16 v[60:63], a[136:139], a[36:39], v[60:63]
    v_cvt_pk_bf16_f32 v158, v212, v213
    v_mfma_f32_16x16x32_bf16 v[80:83], a[140:143], a[36:39], v[80:83]
    v_mfma_f32_16x16x32_bf16 v[112:115], a[144:147], a[36:39], v[112:115]
    v_mfma_f32_16x16x32_bf16 v[144:147], a[148:151], a[36:39], v[144:147]
    s_waitcnt lgkmcnt(0)
    v_mfma_f32_16x16x32_bf16 v[44:47], a[152:155], a[0:3], v[44:47]
    ds_read_b128 a[20:23], v16 offset:15360
    v_mfma_f32_16x16x32_bf16 v[64:67], a[156:159], a[0:3], v[64:67]
    ds_read_b128 a[24:27], v16 offset:16384
    v_mfma_f32_16x16x32_bf16 v[96:99], a[160:163], a[0:3], v[96:99]
    ds_read_b128 a[28:31], v16 offset:17408
    ds_read_b128 a[32:35], v16 offset:18432
    v_mfma_f32_16x16x32_bf16 v[128:131], a[164:167], a[0:3], v[128:131]
    ds_read_b128 a[36:39], v16 offset:19456
    v_mfma_f32_16x16x32_bf16 v[48:51], a[152:155], a[4:7], v[48:51]
    v_cvt_pk_bf16_f32 v159, v214, v215
    s_mov_b32 s47, 16384
    buffer_store_dwordx4 v[156:159], v16, s[36:39], s47 offen sc1
    v_mfma_f32_16x16x32_bf16 v[68:71], a[156:159], a[4:7], v[68:71]
    v_accvgpr_read_b32 v216, a228
    v_mfma_f32_16x16x32_bf16 v[100:103], a[160:163], a[4:7], v[100:103]
    v_accvgpr_read_b32 v217, a229
    v_mfma_f32_16x16x32_bf16 v[132:135], a[164:167], a[4:7], v[132:135]
    v_accvgpr_read_b32 v218, a230
    v_accvgpr_read_b32 v219, a231
    v_mfma_f32_16x16x32_bf16 v[52:55], a[152:155], a[8:11], v[52:55]
    v_cvt_pk_bf16_f32 v180, v216, v217
    v_mfma_f32_16x16x32_bf16 v[72:75], a[156:159], a[8:11], v[72:75]
    v_cvt_pk_bf16_f32 v181, v218, v219
    v_accvgpr_read_b32 v220, a248
    v_mfma_f32_16x16x32_bf16 v[104:107], a[160:163], a[8:11], v[104:107]
    v_accvgpr_read_b32 v221, a249
    v_mfma_f32_16x16x32_bf16 v[136:139], a[164:167], a[8:11], v[136:139]
    v_accvgpr_read_b32 v222, a250
    v_mfma_f32_16x16x32_bf16 v[56:59], a[152:155], a[12:15], v[56:59]
    v_accvgpr_read_b32 v223, a251
    v_cvt_pk_bf16_f32 v182, v220, v221
    v_mfma_f32_16x16x32_bf16 v[76:79], a[156:159], a[12:15], v[76:79]
    v_cvt_pk_bf16_f32 v183, v222, v223
    v_mfma_f32_16x16x32_bf16 v[108:111], a[160:163], a[12:15], v[108:111]
    s_mov_b32 s47, 98304
    buffer_store_dwordx4 v[180:183], v16, s[36:39], s47 offen sc1
    v_accvgpr_read_b32 v184, a192
    v_mfma_f32_16x16x32_bf16 v[140:143], a[164:167], a[12:15], v[140:143]
    v_accvgpr_read_b32 v185, a193
    v_mfma_f32_16x16x32_bf16 v[60:63], a[152:155], a[16:19], v[60:63]
    v_accvgpr_read_b32 v186, a194
    v_mfma_f32_16x16x32_bf16 v[80:83], a[156:159], a[16:19], v[80:83]
    v_mfma_f32_16x16x32_bf16 v[112:115], a[160:163], a[16:19], v[112:115]
    v_mfma_f32_16x16x32_bf16 v[144:147], a[164:167], a[16:19], v[144:147]
    s_waitcnt lgkmcnt(0)
    v_mfma_f32_16x16x32_bf16 v[44:47], a[168:171], a[20:23], v[44:47]
    ds_read_b128 a[0:3], v16 offset:20480
    v_mfma_f32_16x16x32_bf16 v[64:67], a[172:175], a[20:23], v[64:67]
    ds_read_b128 a[4:7], v16 offset:21504
    v_mfma_f32_16x16x32_bf16 v[96:99], a[176:179], a[20:23], v[96:99]
    ds_read_b128 a[8:11], v16 offset:22528
    ds_read_b128 a[12:15], v16 offset:23552
    v_mfma_f32_16x16x32_bf16 v[128:131], a[180:183], a[20:23], v[128:131]
    ds_read_b128 a[16:19], v16 offset:24576
    v_mfma_f32_16x16x32_bf16 v[48:51], a[168:171], a[24:27], v[48:51]
    v_accvgpr_read_b32 v187, a195
    v_cvt_pk_bf16_f32 v244, v184, v185
    v_mfma_f32_16x16x32_bf16 v[68:71], a[172:175], a[24:27], v[68:71]
    v_cvt_pk_bf16_f32 v245, v186, v187
    v_mfma_f32_16x16x32_bf16 v[100:103], a[176:179], a[24:27], v[100:103]
    v_accvgpr_read_b32 v188, a212
    v_accvgpr_read_b32 v189, a213
    v_mfma_f32_16x16x32_bf16 v[132:135], a[180:183], a[24:27], v[132:135]
    v_accvgpr_read_b32 v190, a214
    v_mfma_f32_16x16x32_bf16 v[52:55], a[168:171], a[28:31], v[52:55]
    v_accvgpr_read_b32 v191, a215
    v_cvt_pk_bf16_f32 v246, v188, v189
    v_mfma_f32_16x16x32_bf16 v[72:75], a[172:175], a[28:31], v[72:75]
    v_cvt_pk_bf16_f32 v247, v190, v191
    v_mfma_f32_16x16x32_bf16 v[104:107], a[176:179], a[28:31], v[104:107]
    s_mov_b32 s47, 32768
    buffer_store_dwordx4 v[244:247], v16, s[36:39], s47 offen sc1
    v_mfma_f32_16x16x32_bf16 v[136:139], a[180:183], a[28:31], v[136:139]
    v_accvgpr_read_b32 v212, a232
    v_accvgpr_read_b32 v213, a233
    v_mfma_f32_16x16x32_bf16 v[56:59], a[168:171], a[32:35], v[56:59]
    v_accvgpr_read_b32 v214, a234
    v_mfma_f32_16x16x32_bf16 v[76:79], a[172:175], a[32:35], v[76:79]
    v_accvgpr_read_b32 v215, a235
    v_cvt_pk_bf16_f32 v248, v212, v213
    v_mfma_f32_16x16x32_bf16 v[108:111], a[176:179], a[32:35], v[108:111]
    v_cvt_pk_bf16_f32 v249, v214, v215
    v_mfma_f32_16x16x32_bf16 v[140:143], a[180:183], a[32:35], v[140:143]
    v_accvgpr_read_b32 v216, a252
    v_accvgpr_read_b32 v217, a253
    v_mfma_f32_16x16x32_bf16 v[60:63], a[168:171], a[36:39], v[60:63]
    v_accvgpr_read_b32 v218, a254
    v_mfma_f32_16x16x32_bf16 v[80:83], a[172:175], a[36:39], v[80:83]
    v_mfma_f32_16x16x32_bf16 v[112:115], a[176:179], a[36:39], v[112:115]
    v_mfma_f32_16x16x32_bf16 v[144:147], a[180:183], a[36:39], v[144:147]
    s_waitcnt lgkmcnt(0)
    v_mfma_f32_16x16x32_bf16 v[44:47], v[160:163], a[0:3], v[44:47]
    ds_read_b128 a[20:23], v16 offset:25600
    v_mfma_f32_16x16x32_bf16 v[64:67], v[164:167], a[0:3], v[64:67]
    ds_read_b128 a[24:27], v16 offset:26624
    v_mfma_f32_16x16x32_bf16 v[96:99], v[168:171], a[0:3], v[96:99]
    ds_read_b128 a[28:31], v16 offset:27648
    ds_read_b128 a[32:35], v16 offset:28672
    v_mfma_f32_16x16x32_bf16 v[128:131], v[172:175], a[0:3], v[128:131]
    ds_read_b128 a[36:39], v16 offset:29696
    v_mfma_f32_16x16x32_bf16 v[48:51], v[160:163], a[4:7], v[48:51]
    v_accvgpr_read_b32 v219, a255
    v_cvt_pk_bf16_f32 v250, v216, v217
    v_mfma_f32_16x16x32_bf16 v[68:71], v[164:167], a[4:7], v[68:71]
    v_cvt_pk_bf16_f32 v251, v218, v219
    v_mfma_f32_16x16x32_bf16 v[100:103], v[168:171], a[4:7], v[100:103]
    s_mov_b32 s47, 114688
    buffer_store_dwordx4 v[248:251], v16, s[36:39], s47 offen sc1
    v_mfma_f32_16x16x32_bf16 v[132:135], v[172:175], a[4:7], v[132:135]
    v_accvgpr_read_b32 v220, a196
    v_accvgpr_read_b32 v221, a197
    v_mfma_f32_16x16x32_bf16 v[52:55], v[160:163], a[8:11], v[52:55]
    v_accvgpr_read_b32 v222, a198
    v_mfma_f32_16x16x32_bf16 v[72:75], v[164:167], a[8:11], v[72:75]
    v_accvgpr_read_b32 v223, a199
    v_cvt_pk_bf16_f32 v252, v220, v221
    v_mfma_f32_16x16x32_bf16 v[104:107], v[168:171], a[8:11], v[104:107]
    v_cvt_pk_bf16_f32 v253, v222, v223
    v_mfma_f32_16x16x32_bf16 v[136:139], v[172:175], a[8:11], v[136:139]
    v_accvgpr_read_b32 v184, a216
    v_mfma_f32_16x16x32_bf16 v[56:59], v[160:163], a[12:15], v[56:59]
    v_accvgpr_read_b32 v185, a217
    v_accvgpr_read_b32 v186, a218
    v_mfma_f32_16x16x32_bf16 v[76:79], v[164:167], a[12:15], v[76:79]
    v_accvgpr_read_b32 v187, a219
    v_mfma_f32_16x16x32_bf16 v[108:111], v[168:171], a[12:15], v[108:111]
    v_cvt_pk_bf16_f32 v254, v184, v185
    v_cvt_pk_bf16_f32 v255, v186, v187
    v_mfma_f32_16x16x32_bf16 v[140:143], v[172:175], a[12:15], v[140:143]
    s_mov_b32 s47, 49152
    buffer_store_dwordx4 v[252:255], v16, s[36:39], s47 offen sc1
    v_mfma_f32_16x16x32_bf16 v[60:63], v[160:163], a[16:19], v[60:63]
    v_accvgpr_read_b32 v188, a236
    v_mfma_f32_16x16x32_bf16 v[80:83], v[164:167], a[16:19], v[80:83]
    v_mfma_f32_16x16x32_bf16 v[112:115], v[168:171], a[16:19], v[112:115]
    v_mfma_f32_16x16x32_bf16 v[144:147], v[172:175], a[16:19], v[144:147]
    s_waitcnt lgkmcnt(0)
    v_mfma_f32_16x16x32_bf16 v[44:47], v[176:179], a[20:23], v[44:47]
    ds_read_b128 a[0:3], v16 offset:30720
    v_mfma_f32_16x16x32_bf16 v[64:67], v[192:195], a[20:23], v[64:67]
    ds_read_b128 a[4:7], v16 offset:31744
    v_mfma_f32_16x16x32_bf16 v[96:99], v[196:199], a[20:23], v[96:99]
    ds_read_b128 a[8:11], v16 offset:32768
    ds_read_b128 a[12:15], v16 offset:33792
    v_mfma_f32_16x16x32_bf16 v[128:131], v[200:203], a[20:23], v[128:131]
    ds_read_b128 a[16:19], v16 offset:34816
    v_mfma_f32_16x16x32_bf16 v[48:51], v[176:179], a[24:27], v[48:51]
    v_accvgpr_read_b32 v189, a237
    v_accvgpr_read_b32 v190, a238
    v_mfma_f32_16x16x32_bf16 v[68:71], v[192:195], a[24:27], v[68:71]
    v_accvgpr_read_b32 v191, a239
    v_mfma_f32_16x16x32_bf16 v[100:103], v[196:199], a[24:27], v[100:103]
    v_cvt_pk_bf16_f32 v124, v188, v189
    v_cvt_pk_bf16_f32 v125, v190, v191
    v_mfma_f32_16x16x32_bf16 v[132:135], v[200:203], a[24:27], v[132:135]
    v_accvgpr_read_b32 v212, a40
    v_mfma_f32_16x16x32_bf16 v[52:55], v[176:179], a[28:31], v[52:55]
    v_accvgpr_read_b32 v213, a41
    v_accvgpr_read_b32 v214, a42
    v_mfma_f32_16x16x32_bf16 v[72:75], v[192:195], a[28:31], v[72:75]
    v_accvgpr_read_b32 v215, a43
    v_mfma_f32_16x16x32_bf16 v[104:107], v[196:199], a[28:31], v[104:107]
    v_cvt_pk_bf16_f32 v126, v212, v213
    v_mfma_f32_16x16x32_bf16 v[136:139], v[200:203], a[28:31], v[136:139]
    v_cvt_pk_bf16_f32 v127, v214, v215
    s_mov_b32 s47, 131072
    buffer_store_dwordx4 v[124:127], v16, s[36:39], s47 offen sc1
    v_mfma_f32_16x16x32_bf16 v[56:59], v[176:179], a[32:35], v[56:59]
    v_accvgpr_read_b32 v216, a200
    v_mfma_f32_16x16x32_bf16 v[76:79], v[192:195], a[32:35], v[76:79]
    v_accvgpr_read_b32 v217, a201
    v_accvgpr_read_b32 v218, a202
    v_mfma_f32_16x16x32_bf16 v[108:111], v[196:199], a[32:35], v[108:111]
    v_accvgpr_read_b32 v219, a203
    v_mfma_f32_16x16x32_bf16 v[140:143], v[200:203], a[32:35], v[140:143]
    v_cvt_pk_bf16_f32 v88, v216, v217
    v_cvt_pk_bf16_f32 v89, v218, v219
    v_mfma_f32_16x16x32_bf16 v[60:63], v[176:179], a[36:39], v[60:63]
    v_accvgpr_read_b32 v220, a220
    v_mfma_f32_16x16x32_bf16 v[80:83], v[192:195], a[36:39], v[80:83]
    v_mfma_f32_16x16x32_bf16 v[112:115], v[196:199], a[36:39], v[112:115]
    v_mfma_f32_16x16x32_bf16 v[144:147], v[200:203], a[36:39], v[144:147]
    s_waitcnt lgkmcnt(0)
    v_mfma_f32_16x16x32_bf16 v[44:47], v[204:207], a[0:3], v[44:47]
    ds_read_b128 a[20:23], v16 offset:35840
    v_mfma_f32_16x16x32_bf16 v[64:67], v[208:211], a[0:3], v[64:67]
    ds_read_b128 a[24:27], v16 offset:36864
    v_mfma_f32_16x16x32_bf16 v[96:99], v[224:227], a[0:3], v[96:99]
    ds_read_b128 a[28:31], v16 offset:37888
    ds_read_b128 a[32:35], v16 offset:38912
    v_mfma_f32_16x16x32_bf16 v[128:131], v[228:231], a[0:3], v[128:131]
    ds_read_b128 a[36:39], v16 offset:39936
    v_mfma_f32_16x16x32_bf16 v[48:51], v[204:207], a[4:7], v[48:51]
    v_accvgpr_read_b32 v221, a221
    v_accvgpr_read_b32 v222, a222
    v_mfma_f32_16x16x32_bf16 v[68:71], v[208:211], a[4:7], v[68:71]
    v_accvgpr_read_b32 v223, a223
    v_mfma_f32_16x16x32_bf16 v[100:103], v[224:227], a[4:7], v[100:103]
    v_cvt_pk_bf16_f32 v90, v220, v221
    v_cvt_pk_bf16_f32 v91, v222, v223
    v_mfma_f32_16x16x32_bf16 v[132:135], v[228:231], a[4:7], v[132:135]
    s_mov_b32 s47, 65536
    buffer_store_dwordx4 v[88:91], v16, s[36:39], s47 offen sc1
    v_mfma_f32_16x16x32_bf16 v[52:55], v[204:207], a[8:11], v[52:55]
    v_accvgpr_read_b32 v184, a240
    v_accvgpr_read_b32 v185, a241
    v_mfma_f32_16x16x32_bf16 v[72:75], v[208:211], a[8:11], v[72:75]
    v_accvgpr_read_b32 v186, a242
    v_mfma_f32_16x16x32_bf16 v[104:107], v[224:227], a[8:11], v[104:107]
    v_accvgpr_read_b32 v187, a243
    v_mfma_f32_16x16x32_bf16 v[136:139], v[228:231], a[8:11], v[136:139]
    v_cvt_pk_bf16_f32 v92, v184, v185
    v_cvt_pk_bf16_f32 v93, v186, v187
    v_mfma_f32_16x16x32_bf16 v[56:59], v[204:207], a[12:15], v[56:59]
    v_accvgpr_read_b32 v188, a44
    v_mfma_f32_16x16x32_bf16 v[76:79], v[208:211], a[12:15], v[76:79]
    v_accvgpr_read_b32 v189, a45
    v_accvgpr_read_b32 v190, a46
    v_mfma_f32_16x16x32_bf16 v[108:111], v[224:227], a[12:15], v[108:111]
    v_accvgpr_read_b32 v191, a47
    v_mfma_f32_16x16x32_bf16 v[140:143], v[228:231], a[12:15], v[140:143]
    v_cvt_pk_bf16_f32 v94, v188, v189
    v_cvt_pk_bf16_f32 v95, v190, v191
    v_mfma_f32_16x16x32_bf16 v[60:63], v[204:207], a[16:19], v[60:63]
    s_mov_b32 s47, 147456
    buffer_store_dwordx4 v[92:95], v16, s[36:39], s47 offen sc1
    v_mfma_f32_16x16x32_bf16 v[80:83], v[208:211], a[16:19], v[80:83]
    v_mfma_f32_16x16x32_bf16 v[112:115], v[224:227], a[16:19], v[112:115]
    v_mfma_f32_16x16x32_bf16 v[144:147], v[228:231], a[16:19], v[144:147]
    s_waitcnt lgkmcnt(0)
    v_mfma_f32_16x16x32_bf16 v[44:47], v[232:235], a[20:23], v[44:47]
    v_mfma_f32_16x16x32_bf16 v[64:67], v[236:239], a[20:23], v[64:67]
    v_mfma_f32_16x16x32_bf16 v[96:99], v[240:243], a[20:23], v[96:99]
    v_mfma_f32_16x16x32_bf16 v[128:131], v[84:87], a[20:23], v[128:131]
    v_mfma_f32_16x16x32_bf16 v[48:51], v[232:235], a[24:27], v[48:51]
    v_mfma_f32_16x16x32_bf16 v[68:71], v[236:239], a[24:27], v[68:71]
    v_mfma_f32_16x16x32_bf16 v[100:103], v[240:243], a[24:27], v[100:103]
    v_mfma_f32_16x16x32_bf16 v[132:135], v[84:87], a[24:27], v[132:135]
    v_mfma_f32_16x16x32_bf16 v[52:55], v[232:235], a[28:31], v[52:55]
    v_mfma_f32_16x16x32_bf16 v[72:75], v[236:239], a[28:31], v[72:75]
    v_mfma_f32_16x16x32_bf16 v[104:107], v[240:243], a[28:31], v[104:107]
    v_mfma_f32_16x16x32_bf16 v[136:139], v[84:87], a[28:31], v[136:139]
    v_mfma_f32_16x16x32_bf16 v[56:59], v[232:235], a[32:35], v[56:59]
    v_mfma_f32_16x16x32_bf16 v[76:79], v[236:239], a[32:35], v[76:79]
    v_mfma_f32_16x16x32_bf16 v[108:111], v[240:243], a[32:35], v[108:111]
    v_mfma_f32_16x16x32_bf16 v[140:143], v[84:87], a[32:35], v[140:143]
    v_mfma_f32_16x16x32_bf16 v[60:63], v[232:235], a[36:39], v[60:63]
    v_mfma_f32_16x16x32_bf16 v[80:83], v[236:239], a[36:39], v[80:83]
    v_mfma_f32_16x16x32_bf16 v[112:115], v[240:243], a[36:39], v[112:115]
    v_mfma_f32_16x16x32_bf16 v[144:147], v[84:87], a[36:39], v[144:147]
    v_cvt_pk_bf16_f32 v148, v44, v45
    v_cvt_pk_bf16_f32 v149, v46, v47
    v_cvt_pk_bf16_f32 v150, v64, v65
    v_cvt_pk_bf16_f32 v151, v66, v67
    s_mov_b32 s47, 163840
    buffer_store_dwordx4 v[148:151], v16, s[36:39], s47 offen sc1
    v_cvt_pk_bf16_f32 v152, v96, v97
    v_cvt_pk_bf16_f32 v153, v98, v99
    v_cvt_pk_bf16_f32 v154, v128, v129
    v_cvt_pk_bf16_f32 v155, v130, v131
    s_mov_b32 s47, 245760
    buffer_store_dwordx4 v[152:155], v16, s[36:39], s47 offen sc1
    v_cvt_pk_bf16_f32 v156, v48, v49
    v_cvt_pk_bf16_f32 v157, v50, v51
    v_cvt_pk_bf16_f32 v158, v68, v69
    v_cvt_pk_bf16_f32 v159, v70, v71
    s_mov_b32 s47, 180224
    buffer_store_dwordx4 v[156:159], v16, s[36:39], s47 offen sc1
    v_cvt_pk_bf16_f32 v180, v100, v101
    v_cvt_pk_bf16_f32 v181, v102, v103
    v_cvt_pk_bf16_f32 v182, v132, v133
    v_cvt_pk_bf16_f32 v183, v134, v135
    s_mov_b32 s47, 262144
    buffer_store_dwordx4 v[180:183], v16, s[36:39], s47 offen sc1
    v_cvt_pk_bf16_f32 v244, v52, v53
    v_cvt_pk_bf16_f32 v245, v54, v55
    v_cvt_pk_bf16_f32 v246, v72, v73
    v_cvt_pk_bf16_f32 v247, v74, v75
    s_mov_b32 s47, 196608
    buffer_store_dwordx4 v[244:247], v16, s[36:39], s47 offen sc1
    v_cvt_pk_bf16_f32 v248, v104, v105
    v_cvt_pk_bf16_f32 v249, v106, v107
    v_cvt_pk_bf16_f32 v250, v136, v137
    v_cvt_pk_bf16_f32 v251, v138, v139
    s_mov_b32 s47, 278528
    buffer_store_dwordx4 v[248:251], v16, s[36:39], s47 offen sc1
    v_cvt_pk_bf16_f32 v252, v56, v57
    v_cvt_pk_bf16_f32 v253, v58, v59
    v_cvt_pk_bf16_f32 v254, v76, v77
    v_cvt_pk_bf16_f32 v255, v78, v79
    s_mov_b32 s47, 212992
    buffer_store_dwordx4 v[252:255], v16, s[36:39], s47 offen sc1
    v_cvt_pk_bf16_f32 v124, v108, v109
    v_cvt_pk_bf16_f32 v125, v110, v111
    v_cvt_pk_bf16_f32 v126, v140, v141
    v_cvt_pk_bf16_f32 v127, v142, v143
    s_mov_b32 s47, 294912
    buffer_store_dwordx4 v[124:127], v16, s[36:39], s47 offen sc1
    v_cvt_pk_bf16_f32 v88, v60, v61
    v_cvt_pk_bf16_f32 v89, v62, v63
    v_cvt_pk_bf16_f32 v90, v80, v81
    v_cvt_pk_bf16_f32 v91, v82, v83
    s_mov_b32 s47, 229376
    buffer_store_dwordx4 v[88:91], v16, s[36:39], s47 offen sc1
    v_cvt_pk_bf16_f32 v92, v112, v113
    v_cvt_pk_bf16_f32 v93, v114, v115
    v_cvt_pk_bf16_f32 v94, v144, v145
    v_cvt_pk_bf16_f32 v95, v146, v147
    s_mov_b32 s47, 311296
    buffer_store_dwordx4 v[92:95], v16, s[36:39], s47 offen sc1
    s_branch L_attn_fin
L_w3_tail:
    v_accvgpr_read_b32 v212, a184
    v_accvgpr_read_b32 v213, a185
    v_accvgpr_read_b32 v214, a186
    v_accvgpr_read_b32 v215, a187
    v_cvt_pk_bf16_f32 v148, v212, v213
    v_cvt_pk_bf16_f32 v149, v214, v215
    v_accvgpr_read_b32 v216, a204
    v_accvgpr_read_b32 v217, a205
    v_accvgpr_read_b32 v218, a206
    v_accvgpr_read_b32 v219, a207
    v_cvt_pk_bf16_f32 v150, v216, v217
    v_cvt_pk_bf16_f32 v151, v218, v219
    s_mov_b32 s47, 0
    buffer_store_dwordx4 v[148:151], v16, s[36:39], s47 offen sc1
    v_accvgpr_read_b32 v220, a224
    v_accvgpr_read_b32 v221, a225
    v_accvgpr_read_b32 v222, a226
    v_accvgpr_read_b32 v223, a227
    v_cvt_pk_bf16_f32 v152, v220, v221
    v_cvt_pk_bf16_f32 v153, v222, v223
    v_accvgpr_read_b32 v184, a244
    v_accvgpr_read_b32 v185, a245
    v_accvgpr_read_b32 v186, a246
    v_accvgpr_read_b32 v187, a247
    v_cvt_pk_bf16_f32 v154, v184, v185
    v_cvt_pk_bf16_f32 v155, v186, v187
    s_mov_b32 s47, 81920
    buffer_store_dwordx4 v[152:155], v16, s[36:39], s47 offen sc1
    v_accvgpr_read_b32 v188, a188
    v_accvgpr_read_b32 v189, a189
    v_accvgpr_read_b32 v190, a190
    v_accvgpr_read_b32 v191, a191
    v_cvt_pk_bf16_f32 v156, v188, v189
    v_cvt_pk_bf16_f32 v157, v190, v191
    v_accvgpr_read_b32 v212, a208
    v_accvgpr_read_b32 v213, a209
    v_accvgpr_read_b32 v214, a210
    v_accvgpr_read_b32 v215, a211
    v_cvt_pk_bf16_f32 v158, v212, v213
    v_cvt_pk_bf16_f32 v159, v214, v215
    s_mov_b32 s47, 16384
    buffer_store_dwordx4 v[156:159], v16, s[36:39], s47 offen sc1
    v_accvgpr_read_b32 v216, a228
    v_accvgpr_read_b32 v217, a229
    v_accvgpr_read_b32 v218, a230
    v_accvgpr_read_b32 v219, a231
    v_cvt_pk_bf16_f32 v180, v216, v217
    v_cvt_pk_bf16_f32 v181, v218, v219
    v_accvgpr_read_b32 v220, a248
    v_accvgpr_read_b32 v221, a249
    v_accvgpr_read_b32 v222, a250
    v_accvgpr_read_b32 v223, a251
    v_cvt_pk_bf16_f32 v182, v220, v221
    v_cvt_pk_bf16_f32 v183, v222, v223
    s_mov_b32 s47, 98304
    buffer_store_dwordx4 v[180:183], v16, s[36:39], s47 offen sc1
    v_accvgpr_read_b32 v184, a192
    v_accvgpr_read_b32 v185, a193
    v_accvgpr_read_b32 v186, a194
    v_accvgpr_read_b32 v187, a195
    v_cvt_pk_bf16_f32 v244, v184, v185
    v_cvt_pk_bf16_f32 v245, v186, v187
    v_accvgpr_read_b32 v188, a212
    v_accvgpr_read_b32 v189, a213
    v_accvgpr_read_b32 v190, a214
    v_accvgpr_read_b32 v191, a215
    v_cvt_pk_bf16_f32 v246, v188, v189
    v_cvt_pk_bf16_f32 v247, v190, v191
    s_mov_b32 s47, 32768
    buffer_store_dwordx4 v[244:247], v16, s[36:39], s47 offen sc1
    v_accvgpr_read_b32 v212, a232
    v_accvgpr_read_b32 v213, a233
    v_accvgpr_read_b32 v214, a234
    v_accvgpr_read_b32 v215, a235
    v_cvt_pk_bf16_f32 v248, v212, v213
    v_cvt_pk_bf16_f32 v249, v214, v215
    v_accvgpr_read_b32 v216, a252
    v_accvgpr_read_b32 v217, a253
    v_accvgpr_read_b32 v218, a254
    v_accvgpr_read_b32 v219, a255
    v_cvt_pk_bf16_f32 v250, v216, v217
    v_cvt_pk_bf16_f32 v251, v218, v219
    s_mov_b32 s47, 114688
    buffer_store_dwordx4 v[248:251], v16, s[36:39], s47 offen sc1
    v_accvgpr_read_b32 v220, a196
    v_accvgpr_read_b32 v221, a197
    v_accvgpr_read_b32 v222, a198
    v_accvgpr_read_b32 v223, a199
    v_cvt_pk_bf16_f32 v252, v220, v221
    v_cvt_pk_bf16_f32 v253, v222, v223
    v_accvgpr_read_b32 v184, a216
    v_accvgpr_read_b32 v185, a217
    v_accvgpr_read_b32 v186, a218
    v_accvgpr_read_b32 v187, a219
    v_cvt_pk_bf16_f32 v254, v184, v185
    v_cvt_pk_bf16_f32 v255, v186, v187
    s_mov_b32 s47, 49152
    buffer_store_dwordx4 v[252:255], v16, s[36:39], s47 offen sc1
    v_accvgpr_read_b32 v188, a236
    v_accvgpr_read_b32 v189, a237
    v_accvgpr_read_b32 v190, a238
    v_accvgpr_read_b32 v191, a239
    v_cvt_pk_bf16_f32 v124, v188, v189
    v_cvt_pk_bf16_f32 v125, v190, v191
    v_accvgpr_read_b32 v212, a40
    v_accvgpr_read_b32 v213, a41
    v_accvgpr_read_b32 v214, a42
    v_accvgpr_read_b32 v215, a43
    v_cvt_pk_bf16_f32 v126, v212, v213
    v_cvt_pk_bf16_f32 v127, v214, v215
    s_mov_b32 s47, 131072
    buffer_store_dwordx4 v[124:127], v16, s[36:39], s47 offen sc1
    v_accvgpr_read_b32 v216, a200
    v_accvgpr_read_b32 v217, a201
    v_accvgpr_read_b32 v218, a202
    v_accvgpr_read_b32 v219, a203
    v_cvt_pk_bf16_f32 v88, v216, v217
    v_cvt_pk_bf16_f32 v89, v218, v219
    v_accvgpr_read_b32 v220, a220
    v_accvgpr_read_b32 v221, a221
    v_accvgpr_read_b32 v222, a222
    v_accvgpr_read_b32 v223, a223
    v_cvt_pk_bf16_f32 v90, v220, v221
    v_cvt_pk_bf16_f32 v91, v222, v223
    s_mov_b32 s47, 65536
    buffer_store_dwordx4 v[88:91], v16, s[36:39], s47 offen sc1
    v_accvgpr_read_b32 v184, a240
    v_accvgpr_read_b32 v185, a241
    v_accvgpr_read_b32 v186, a242
    v_accvgpr_read_b32 v187, a243
    v_cvt_pk_bf16_f32 v92, v184, v185
    v_cvt_pk_bf16_f32 v93, v186, v187
    v_accvgpr_read_b32 v188, a44
    v_accvgpr_read_b32 v189, a45
    v_accvgpr_read_b32 v190, a46
    v_accvgpr_read_b32 v191, a47
    v_cvt_pk_bf16_f32 v94, v188, v189
    v_cvt_pk_bf16_f32 v95, v190, v191
    s_mov_b32 s47, 147456
    buffer_store_dwordx4 v[92:95], v16, s[36:39], s47 offen sc1
L_attn_fin:
    s_nop 1
L_attn_end:
    s_endpgm
.p2align 8
.globl oproj_kernel
.type oproj_kernel,@function
oproj_kernel:
    s_cmp_ge_u32 s2, 1120
    s_cbranch_scc1 L_oproj_end
    s_load_dwordx4 s[4:7], s[0:1], 40
    s_load_dwordx2 s[18:19], s[0:1], 56
    v_and_b32 v1, 63, v0
    s_mov_b32 s32, 0
    s_mov_b32 s33, s2
    v_lshlrev_b32 v4, 4, v1
    s_lshl_b32 s34, s33, 14
    s_waitcnt lgkmcnt(0)
    s_add_u32 s20, s18, s34
    s_addc_u32 s21, s19, 0
    s_and_b32 s21, s21, 65535
    s_mov_b32 s22, 16384
    s_mov_b32 s23, 131072
    s_mov_b32 s35, 0
    buffer_load_dwordx4 v[32:35], v4, s[20:23], s35 offen
    buffer_load_dwordx4 v[36:39], v4, s[20:23], s35 offen offset:1024
    buffer_load_dwordx4 v[40:43], v4, s[20:23], s35 offen offset:2048
    buffer_load_dwordx4 v[44:47], v4, s[20:23], s35 offen offset:3072
    s_mov_b32 s35, 4096
    buffer_load_dwordx4 v[48:51], v4, s[20:23], s35 offen
    buffer_load_dwordx4 v[52:55], v4, s[20:23], s35 offen offset:1024
    buffer_load_dwordx4 v[56:59], v4, s[20:23], s35 offen offset:2048
    buffer_load_dwordx4 v[60:63], v4, s[20:23], s35 offen offset:3072
    s_mov_b32 s35, 8192
    buffer_load_dwordx4 v[64:67], v4, s[20:23], s35 offen
    buffer_load_dwordx4 v[68:71], v4, s[20:23], s35 offen offset:1024
    buffer_load_dwordx4 v[72:75], v4, s[20:23], s35 offen offset:2048
    buffer_load_dwordx4 v[76:79], v4, s[20:23], s35 offen offset:3072
    s_mov_b32 s35, 12288
    buffer_load_dwordx4 v[80:83], v4, s[20:23], s35 offen
    buffer_load_dwordx4 v[84:87], v4, s[20:23], s35 offen offset:1024
    buffer_load_dwordx4 v[88:91], v4, s[20:23], s35 offen offset:2048
    buffer_load_dwordx4 v[92:95], v4, s[20:23], s35 offen offset:3072
    s_mul_hi_u32 s34, s33, 858993460
    s_mul_i32 s35, s34, 5
    s_sub_u32 s37, s33, s35
    s_and_b32 s38, s34, 1
    s_lshr_b32 s34, s34, 1
    s_mul_hi_u32 s40, s34, 613566757
    s_mul_i32 s35, s40, 7
    s_sub_u32 s39, s34, s35
    s_mul_i32 s34, s40, 80
    s_lshl_b32 s35, s37, 4
    s_add_u32 s34, s34, s35
    s_mul_i32 s34, s34, 896
    s_lshl_b32 s35, s39, 7
    s_add_u32 s34, s34, s35
    s_lshl_b32 s35, s38, 6
    s_add_u32 s36, s34, s35
    s_add_u32 s24, s4, 0
    s_addc_u32 s25, s5, 0
    s_and_b32 s25, s25, 65535
    s_mov_b32 s26, 1146880
    s_mov_b32 s27, 131072
    v_and_b32 v2, 15, v1
    v_lshrrev_b32 v3, 4, v1
    v_mul_u32_u24 v5, 896, v2
    v_and_b32 v6, 1, v3
    v_lshl_add_u32 v5, v6, 5, v5
    v_lshrrev_b32 v6, 1, v3
    v_lshl_add_u32 v5, v6, 4, v5
    s_waitcnt vmcnt(15)
    v_lshlrev_b32 v16, 16, v32
    v_and_b32 v17, 4294901760, v32
    v_lshlrev_b32 v18, 16, v33
    v_and_b32 v19, 4294901760, v33
    v_lshlrev_b32 v20, 16, v34
    v_and_b32 v21, 4294901760, v34
    v_lshlrev_b32 v22, 16, v35
    v_and_b32 v23, 4294901760, v35
    s_waitcnt vmcnt(14)
    v_lshlrev_b32 v24, 16, v36
    v_and_b32 v25, 4294901760, v36
    v_lshlrev_b32 v26, 16, v37
    v_and_b32 v27, 4294901760, v37
    v_lshlrev_b32 v28, 16, v38
    v_and_b32 v29, 4294901760, v38
    v_lshlrev_b32 v30, 16, v39
    v_and_b32 v31, 4294901760, v39
    v_pk_add_f32 v[16:17], v[16:17], v[24:25]
    v_pk_add_f32 v[18:19], v[18:19], v[26:27]
    v_pk_add_f32 v[20:21], v[20:21], v[28:29]
    v_pk_add_f32 v[22:23], v[22:23], v[30:31]
    s_waitcnt vmcnt(13)
    v_lshlrev_b32 v24, 16, v40
    v_and_b32 v25, 4294901760, v40
    v_lshlrev_b32 v26, 16, v41
    v_and_b32 v27, 4294901760, v41
    v_lshlrev_b32 v28, 16, v42
    v_and_b32 v29, 4294901760, v42
    v_lshlrev_b32 v30, 16, v43
    v_and_b32 v31, 4294901760, v43
    v_pk_add_f32 v[16:17], v[16:17], v[24:25]
    v_pk_add_f32 v[18:19], v[18:19], v[26:27]
    v_pk_add_f32 v[20:21], v[20:21], v[28:29]
    v_pk_add_f32 v[22:23], v[22:23], v[30:31]
    s_waitcnt vmcnt(12)
    v_lshlrev_b32 v24, 16, v44
    v_and_b32 v25, 4294901760, v44
    v_lshlrev_b32 v26, 16, v45
    v_and_b32 v27, 4294901760, v45
    v_lshlrev_b32 v28, 16, v46
    v_and_b32 v29, 4294901760, v46
    v_lshlrev_b32 v30, 16, v47
    v_and_b32 v31, 4294901760, v47
    v_pk_add_f32 v[16:17], v[16:17], v[24:25]
    v_pk_add_f32 v[18:19], v[18:19], v[26:27]
    v_pk_add_f32 v[20:21], v[20:21], v[28:29]
    v_pk_add_f32 v[22:23], v[22:23], v[30:31]
    s_waitcnt vmcnt(11)
    v_lshlrev_b32 v24, 16, v48
    v_and_b32 v25, 4294901760, v48
    v_lshlrev_b32 v26, 16, v49
    v_and_b32 v27, 4294901760, v49
    v_lshlrev_b32 v28, 16, v50
    v_and_b32 v29, 4294901760, v50
    v_lshlrev_b32 v30, 16, v51
    v_and_b32 v31, 4294901760, v51
    v_pk_add_f32 v[16:17], v[16:17], v[24:25]
    v_pk_add_f32 v[18:19], v[18:19], v[26:27]
    v_pk_add_f32 v[20:21], v[20:21], v[28:29]
    v_pk_add_f32 v[22:23], v[22:23], v[30:31]
    s_waitcnt vmcnt(10)
    v_lshlrev_b32 v24, 16, v52
    v_and_b32 v25, 4294901760, v52
    v_lshlrev_b32 v26, 16, v53
    v_and_b32 v27, 4294901760, v53
    v_lshlrev_b32 v28, 16, v54
    v_and_b32 v29, 4294901760, v54
    v_lshlrev_b32 v30, 16, v55
    v_and_b32 v31, 4294901760, v55
    v_pk_add_f32 v[16:17], v[16:17], v[24:25]
    v_pk_add_f32 v[18:19], v[18:19], v[26:27]
    v_pk_add_f32 v[20:21], v[20:21], v[28:29]
    v_pk_add_f32 v[22:23], v[22:23], v[30:31]
    s_waitcnt vmcnt(9)
    v_lshlrev_b32 v24, 16, v56
    v_and_b32 v25, 4294901760, v56
    v_lshlrev_b32 v26, 16, v57
    v_and_b32 v27, 4294901760, v57
    v_lshlrev_b32 v28, 16, v58
    v_and_b32 v29, 4294901760, v58
    v_lshlrev_b32 v30, 16, v59
    v_and_b32 v31, 4294901760, v59
    v_pk_add_f32 v[16:17], v[16:17], v[24:25]
    v_pk_add_f32 v[18:19], v[18:19], v[26:27]
    v_pk_add_f32 v[20:21], v[20:21], v[28:29]
    v_pk_add_f32 v[22:23], v[22:23], v[30:31]
    s_waitcnt vmcnt(8)
    v_lshlrev_b32 v24, 16, v60
    v_and_b32 v25, 4294901760, v60
    v_lshlrev_b32 v26, 16, v61
    v_and_b32 v27, 4294901760, v61
    v_lshlrev_b32 v28, 16, v62
    v_and_b32 v29, 4294901760, v62
    v_lshlrev_b32 v30, 16, v63
    v_and_b32 v31, 4294901760, v63
    v_pk_add_f32 v[16:17], v[16:17], v[24:25]
    v_pk_add_f32 v[18:19], v[18:19], v[26:27]
    v_pk_add_f32 v[20:21], v[20:21], v[28:29]
    v_pk_add_f32 v[22:23], v[22:23], v[30:31]
    s_waitcnt vmcnt(7)
    v_lshlrev_b32 v24, 16, v64
    v_and_b32 v25, 4294901760, v64
    v_lshlrev_b32 v26, 16, v65
    v_and_b32 v27, 4294901760, v65
    v_lshlrev_b32 v28, 16, v66
    v_and_b32 v29, 4294901760, v66
    v_lshlrev_b32 v30, 16, v67
    v_and_b32 v31, 4294901760, v67
    v_pk_add_f32 v[16:17], v[16:17], v[24:25]
    v_pk_add_f32 v[18:19], v[18:19], v[26:27]
    v_pk_add_f32 v[20:21], v[20:21], v[28:29]
    v_pk_add_f32 v[22:23], v[22:23], v[30:31]
    s_waitcnt vmcnt(6)
    v_lshlrev_b32 v24, 16, v68
    v_and_b32 v25, 4294901760, v68
    v_lshlrev_b32 v26, 16, v69
    v_and_b32 v27, 4294901760, v69
    v_lshlrev_b32 v28, 16, v70
    v_and_b32 v29, 4294901760, v70
    v_lshlrev_b32 v30, 16, v71
    v_and_b32 v31, 4294901760, v71
    v_pk_add_f32 v[16:17], v[16:17], v[24:25]
    v_pk_add_f32 v[18:19], v[18:19], v[26:27]
    v_pk_add_f32 v[20:21], v[20:21], v[28:29]
    v_pk_add_f32 v[22:23], v[22:23], v[30:31]
    s_waitcnt vmcnt(5)
    v_lshlrev_b32 v24, 16, v72
    v_and_b32 v25, 4294901760, v72
    v_lshlrev_b32 v26, 16, v73
    v_and_b32 v27, 4294901760, v73
    v_lshlrev_b32 v28, 16, v74
    v_and_b32 v29, 4294901760, v74
    v_lshlrev_b32 v30, 16, v75
    v_and_b32 v31, 4294901760, v75
    v_pk_add_f32 v[16:17], v[16:17], v[24:25]
    v_pk_add_f32 v[18:19], v[18:19], v[26:27]
    v_pk_add_f32 v[20:21], v[20:21], v[28:29]
    v_pk_add_f32 v[22:23], v[22:23], v[30:31]
    s_waitcnt vmcnt(4)
    v_lshlrev_b32 v24, 16, v76
    v_and_b32 v25, 4294901760, v76
    v_lshlrev_b32 v26, 16, v77
    v_and_b32 v27, 4294901760, v77
    v_lshlrev_b32 v28, 16, v78
    v_and_b32 v29, 4294901760, v78
    v_lshlrev_b32 v30, 16, v79
    v_and_b32 v31, 4294901760, v79
    v_pk_add_f32 v[16:17], v[16:17], v[24:25]
    v_pk_add_f32 v[18:19], v[18:19], v[26:27]
    v_pk_add_f32 v[20:21], v[20:21], v[28:29]
    v_pk_add_f32 v[22:23], v[22:23], v[30:31]
    s_waitcnt vmcnt(3)
    v_lshlrev_b32 v24, 16, v80
    v_and_b32 v25, 4294901760, v80
    v_lshlrev_b32 v26, 16, v81
    v_and_b32 v27, 4294901760, v81
    v_lshlrev_b32 v28, 16, v82
    v_and_b32 v29, 4294901760, v82
    v_lshlrev_b32 v30, 16, v83
    v_and_b32 v31, 4294901760, v83
    v_pk_add_f32 v[16:17], v[16:17], v[24:25]
    v_pk_add_f32 v[18:19], v[18:19], v[26:27]
    v_pk_add_f32 v[20:21], v[20:21], v[28:29]
    v_pk_add_f32 v[22:23], v[22:23], v[30:31]
    s_waitcnt vmcnt(2)
    v_lshlrev_b32 v24, 16, v84
    v_and_b32 v25, 4294901760, v84
    v_lshlrev_b32 v26, 16, v85
    v_and_b32 v27, 4294901760, v85
    v_lshlrev_b32 v28, 16, v86
    v_and_b32 v29, 4294901760, v86
    v_lshlrev_b32 v30, 16, v87
    v_and_b32 v31, 4294901760, v87
    v_pk_add_f32 v[16:17], v[16:17], v[24:25]
    v_pk_add_f32 v[18:19], v[18:19], v[26:27]
    v_pk_add_f32 v[20:21], v[20:21], v[28:29]
    v_pk_add_f32 v[22:23], v[22:23], v[30:31]
    s_waitcnt vmcnt(1)
    v_lshlrev_b32 v24, 16, v88
    v_and_b32 v25, 4294901760, v88
    v_lshlrev_b32 v26, 16, v89
    v_and_b32 v27, 4294901760, v89
    v_lshlrev_b32 v28, 16, v90
    v_and_b32 v29, 4294901760, v90
    v_lshlrev_b32 v30, 16, v91
    v_and_b32 v31, 4294901760, v91
    v_pk_add_f32 v[16:17], v[16:17], v[24:25]
    v_pk_add_f32 v[18:19], v[18:19], v[26:27]
    v_pk_add_f32 v[20:21], v[20:21], v[28:29]
    v_pk_add_f32 v[22:23], v[22:23], v[30:31]
    s_waitcnt vmcnt(0)
    v_lshlrev_b32 v24, 16, v92
    v_and_b32 v25, 4294901760, v92
    v_lshlrev_b32 v26, 16, v93
    v_and_b32 v27, 4294901760, v93
    v_lshlrev_b32 v28, 16, v94
    v_and_b32 v29, 4294901760, v94
    v_lshlrev_b32 v30, 16, v95
    v_and_b32 v31, 4294901760, v95
    v_pk_add_f32 v[16:17], v[16:17], v[24:25]
    v_pk_add_f32 v[18:19], v[18:19], v[26:27]
    v_pk_add_f32 v[20:21], v[20:21], v[28:29]
    v_pk_add_f32 v[22:23], v[22:23], v[30:31]
    v_cvt_pk_bf16_f32 v8, v16, v17
    v_cvt_pk_bf16_f32 v9, v18, v19
    v_cvt_pk_bf16_f32 v10, v20, v21
    v_cvt_pk_bf16_f32 v11, v22, v23
    s_nop 0
    v_permlane16_swap_b32 v8, v10
    v_permlane16_swap_b32 v9, v11
    buffer_store_dwordx4 v[8:11], v5, s[24:27], s36 offen
L_oproj_end:
    s_endpgm
L_code_end:
.section .rodata,"a"
.p2align 6
.amdhsa_kernel attn_kernel
  .amdhsa_next_free_vgpr 512
  .amdhsa_next_free_sgpr 102
  .amdhsa_accum_offset 256
  .amdhsa_group_segment_fixed_size 0
  .amdhsa_kernarg_size 64
  .amdhsa_user_sgpr_count 2
  .amdhsa_user_sgpr_kernarg_segment_ptr 1
  .amdhsa_system_sgpr_workgroup_id_x 1
.end_amdhsa_kernel
.p2align 6
.amdhsa_kernel oproj_kernel
  .amdhsa_next_free_vgpr 96
  .amdhsa_next_free_sgpr 102
  .amdhsa_accum_offset 96
  .amdhsa_group_segment_fixed_size 0
  .amdhsa_kernarg_size 64
  .amdhsa_user_sgpr_count 2
  .amdhsa_user_sgpr_kernarg_segment_ptr 1
  .amdhsa_system_sgpr_workgroup_id_x 1
.end_amdhsa_kernel
```
